```python
import torch

def _softmax(x, axis=-1):
    return torch.softmax(x, dim=axis)
def _gelu(x):
    return torch.nn.functional.gelu(x, approximate="tanh")
def _silu(x):
    return torch.nn.functional.silu(x)
def _sigmoid(x):
    return torch.sigmoid(x)
def _layernorm(x, axis=-1, eps=1e-5):
    m = x.mean(dim=axis, keepdim=True)
    v = x.var(dim=axis, keepdim=True, unbiased=False)
    return (x - m) / torch.sqrt(v + eps)
def _scatter_add(tgt, idx, src, axis=0):
    return tgt.clone().index_add_(axis, idx, src)
def _segment_sum(src, seg, n):
    out = torch.zeros((n,) + src.shape[1:], dtype=src.dtype)
    return out.index_add_(0, seg, src)
def _pad(x, pw):
    flat = tuple(v for pair in reversed(pw) for v in pair)
    return torch.nn.functional.pad(x, flat)

kernel_name = 'recurrent_scan__gqa_block_cached__swiglu_ffn__decode'

def setup_inputs():

    _w = (lambda a: (lambda t: t.to(torch.bfloat16) if t.is_floating_point() else t)(torch.as_tensor(a)))
    def _A_setup():
        B, Sq, D = 4, 1, 512
        Hq, Hkv, Sk, Dh = 32, 8, 4096, 128
        assert Hq % Hkv == 0, (Hq, Hkv)
        return {
            "x": _w((lambda *s: torch.randn(*s, dtype=torch.bfloat16) * 0.05)(B, Sq, D)),
            "k_cache": _w((lambda *s: torch.randn(*s, dtype=torch.bfloat16) * 1.6)(B, Hkv, Sk, Dh)),
            "v_cache": _w((lambda *s: torch.randn(*s, dtype=torch.bfloat16) * 0.2)(B, Hkv, Sk, Dh)),
            "wq": _w((lambda *s: torch.randn(*s, dtype=torch.bfloat16) * 1.6)(D, Hq * Dh) * (D ** -0.5)),
            "wo": _w((lambda *s: torch.randn(*s, dtype=torch.bfloat16) * 0.2)(Hq * Dh, D) * ((Hq * Dh) ** -0.5)),
        }
    _A_in = _A_setup()

    def _B_setup():
        B, S, D, F = 4, 1, 512, 1792
        return {
            "x": _w((lambda *s: torch.randn(*s, dtype=torch.bfloat16) * 0.05)(B, S, D)),
            "w_gate": _w((lambda *s: torch.randn(*s, dtype=torch.bfloat16) * 0.1)(D, F)),
            "w_up": _w((lambda *s: torch.randn(*s, dtype=torch.bfloat16) * 0.1)(D, F)),
            "w_down": _w((lambda *s: torch.randn(*s, dtype=torch.bfloat16) * 0.1)(F, D)),
        }
    _B_in = _B_setup()

    return {
        "A_x": _A_in["x"],
        "A_k_cache": _A_in["k_cache"],
        "A_v_cache": _A_in["v_cache"],
        "A_wq": _A_in["wq"],
        "A_wo": _A_in["wo"],
        "B_x": _B_in["x"],
        "B_w_gate": _B_in["w_gate"],
        "B_w_up": _B_in["w_up"],
        "B_w_down": _B_in["w_down"],
    }

def reference(A_x, A_k_cache, A_v_cache, A_wq, A_wo, B_x, B_w_gate, B_w_up, B_w_down):
    def _A_ref(x, k_cache, v_cache, wq, wo):
        B, Sq, D = x.shape
        Hq, Dh = 32, 128
        Hkv = k_cache.shape[1]
        rep = Hq // Hkv
        q = (lambda x, *d: x.permute(*d))((x @ wq).reshape(B, Sq, Hq, Dh), 0, 2, 1, 3)
        k = (lambda x, n, axis: torch.repeat_interleave(x, n, dim=axis))(k_cache, rep, axis=1)
        v = (lambda x, n, axis: torch.repeat_interleave(x, n, dim=axis))(v_cache, rep, axis=1)
        scores = torch.einsum("bhqd,bhkd->bhqk", q, k) * (Dh ** -0.5)
        p = _softmax(scores, axis=-1)
        o = torch.einsum("bhqk,bhkd->bhqd", p, v)
        return (lambda x, *d: x.permute(*d))(o, 0, 2, 1, 3).reshape(B, Sq, Hq * Dh) @ wo

    def _B_ref(x, w_gate, w_up, w_down):
        g = _silu(x @ w_gate)
        u = x @ w_up
        return (g * u) @ w_down

    x = A_x
    xn = _layernorm(x, axis=-1)
    s = _A_ref(xn, A_k_cache, A_v_cache, A_wq, A_wo)
    g = _silu(_B_ref(xn, B_w_gate, B_w_up, B_w_down))
    return x + s * g
```

```asm
; @launch grid=(256,1,1) block=(576,1,1) lds=95744
.amdgcn_target "amdgcn-amd-amdhsa--gfx950"
.text
.globl recurrent_scan__gqa_block_cached__swiglu_ffn__decode_kernel
.p2align 8
.type recurrent_scan__gqa_block_cached__swiglu_ffn__decode_kernel,@function
recurrent_scan__gqa_block_cached__swiglu_ffn__decode_kernel:
    s_cmp_ge_u32 s2, 256
    s_cbranch_scc1 L_end
    s_load_dwordx16 s[16:31], s[0:1], 0
    s_load_dwordx8 s[32:39], s[0:1], 64
    s_getpc_b64 s[8:9]
L_pc:
    s_sub_u32 s8, s8, L_pc-recurrent_scan__gqa_block_cached__swiglu_ffn__decode_kernel
    s_subb_u32 s9, s9, 0
    s_mov_b32 s10, (L_end-recurrent_scan__gqa_block_cached__swiglu_ffn__decode_kernel)/128
    v_lshlrev_b32 v159, 7, v0
    v_cmp_gt_u32 vcc, s10, v0
    s_nop 0
    s_and_saveexec_b64 s[12:13], vcc
    s_cbranch_execz L_nopf
    global_load_dword v158, v159, s[8:9]
L_nopf:
    s_mov_b64 exec, s[12:13]
    v_lshrrev_b32 v1, 6, v0
    v_and_b32 v0, 63, v0
    v_readfirstlane_b32 s3, v1
    s_and_b32 s4, s2, 7
    s_lshr_b32 s5, s2, 3
    s_lshr_b32 s6, s5, 3
    s_and_b32 s7, s5, 7
    s_sub_u32 s8, s5, 24
    s_cmp_ge_u32 s5, 30
    s_cselect_b32 s60, s8, s5
    s_cselect_b32 s62, 1, 0
    s_add_u32 s8, s5, 8
    s_sub_u32 s9, s5, 16
    s_cmp_lt_u32 s5, 16
    s_cselect_b32 s61, s8, s9
    s_cselect_b32 s9, 1, 0
    s_lshr_b32 s8, s5, 1
    s_cmp_eq_u32 s8, 3
    s_cselect_b32 s9, 0, s9
    s_or_b32 s62, s62, s9
    s_mov_b32 s69, 0xffff0000
    s_mov_b32 s56, 0xffff0000
    s_mov_b32 s57, 0xffff0000
    s_mov_b32 s58, 0
    s_mov_b32 s59, -1
    s_cmp_eq_u32 s3, 0
    s_cbranch_scc1 L_service
    s_sub_u32 s3, s3, 1
    s_mov_b32 s72, 32768
    s_mov_b32 s73, 65536
    s_mov_b32 s74, 98304
    s_lshl_b32 s8, s6, 3
    s_add_u32 s8, s8, s4
    s_lshl_b32 s8, s8, 20
    s_lshl_b32 s9, s7, 17
    s_add_u32 s8, s8, s9
    s_lshl_b32 s9, s3, 12
    s_add_u32 s8, s8, s9
    v_lshrrev_b32 v5, 4, v0
    v_bfe_u32 v7, v0, 2, 2
    v_and_b32 v6, 3, v0
    v_lshlrev_b32 v1, 8, v7
    v_lshl_add_u32 v1, v5, 6, v1
    v_lshl_add_u32 v1, v6, 4, v1
    v_add_u32 v1, s8, v1
    v_lshlrev_b32 v2, 4, v0
    v_add_u32 v2, s8, v2
    v_mul_u32_u24 v3, 320, v6
    v_lshl_add_u32 v3, v5, 6, v3
    v_lshl_add_u32 v3, v7, 4, v3
    v_add_u32 v3, 4480, v3
    s_waitcnt lgkmcnt(0)
    s_mov_b32 s40, s18
    s_and_b32 s41, s19, 0xffff
    s_mov_b32 s42, 0x2000000
    s_mov_b32 s43, 0x20000
    s_mov_b32 s44, s20
    s_and_b32 s45, s21, 0xffff
    s_mov_b32 s46, 0x2000000
    s_mov_b32 s47, 0x20000
    s_barrier
    buffer_load_dwordx4 v[8:11], v1, s[40:43], 0 offen offset:0 nt
    buffer_load_dwordx4 v[12:15], v1, s[40:43], 0 offen offset:1024 nt
    buffer_load_dwordx4 v[16:19], v1, s[40:43], 0 offen offset:2048 nt
    buffer_load_dwordx4 v[20:23], v1, s[40:43], 0 offen offset:3072 nt
    s_waitcnt vmcnt(3)
    buffer_load_dwordx4 v[24:27], v1, s[40:43], s72 offen offset:0 nt
    s_waitcnt vmcnt(3)
    buffer_load_dwordx4 v[28:31], v1, s[40:43], s72 offen offset:1024 nt
    s_waitcnt vmcnt(3)
    buffer_load_dwordx4 v[32:35], v1, s[40:43], s72 offen offset:2048 nt
    s_waitcnt vmcnt(3)
    buffer_load_dwordx4 v[36:39], v1, s[40:43], s72 offen offset:3072 nt
    s_waitcnt vmcnt(3)
    buffer_load_dwordx4 v[40:43], v1, s[40:43], s73 offen offset:0 nt
    s_waitcnt vmcnt(3)
    buffer_load_dwordx4 v[44:47], v1, s[40:43], s73 offen offset:1024 nt
    s_waitcnt vmcnt(3)
    buffer_load_dwordx4 v[48:51], v1, s[40:43], s73 offen offset:2048 nt
    s_waitcnt vmcnt(3)
    buffer_load_dwordx4 v[52:55], v1, s[40:43], s73 offen offset:3072 nt
    s_waitcnt vmcnt(3)
    buffer_load_dwordx4 v[56:59], v1, s[40:43], s74 offen offset:0 nt
    s_waitcnt vmcnt(3)
    buffer_load_dwordx4 v[60:63], v1, s[40:43], s74 offen offset:1024 nt
    s_waitcnt vmcnt(3)
    buffer_load_dwordx4 v[64:67], v1, s[40:43], s74 offen offset:2048 nt
    s_waitcnt vmcnt(3)
    buffer_load_dwordx4 v[68:71], v1, s[40:43], s74 offen offset:3072 nt
    s_waitcnt vmcnt(3)
    buffer_load_dwordx4 v[72:75], v2, s[44:47], 0 offen offset:0 nt
    s_waitcnt vmcnt(3)
    buffer_load_dwordx4 v[76:79], v2, s[44:47], 0 offen offset:1024 nt
    s_waitcnt vmcnt(3)
    buffer_load_dwordx4 v[80:83], v2, s[44:47], 0 offen offset:2048 nt
    s_mov_b32 s64, s38
    s_and_b32 s65, s39, 0xffff
    s_mov_b32 s66, 0x800000
    s_mov_b32 s67, 0x20000
    s_mov_b32 s76, 0x05040100
    s_mov_b32 s77, 0x07060302
    s_waitcnt vmcnt(3)
    buffer_load_dwordx4 v[84:87], v2, s[44:47], 0 offen offset:3072 nt
    buffer_load_dwordx4 v[88:91], v2, s[44:47], s72 offen offset:0 nt
    buffer_load_dwordx4 v[92:95], v2, s[44:47], s72 offen offset:1024 nt
    buffer_load_dwordx4 v[96:99], v2, s[44:47], s72 offen offset:2048 nt
    buffer_load_dwordx4 v[100:103], v2, s[44:47], s72 offen offset:3072 nt
    v_mov_b32 v4, 0
    s_mov_b32 s75, 0
L_qwait:
    ds_read_b64 v[6:7], v4
    s_add_u32 s75, s75, 1
    s_waitcnt lgkmcnt(0)
    v_readfirstlane_b32 s8, v6
    v_readfirstlane_b32 s68, v7
    s_cmp_lg_u32 s8, 0
    s_cbranch_scc1 L_qready
    s_cmp_gt_u32 s75, 2097152
    s_cbranch_scc1 L_qready
    s_sleep 2
    s_branch L_qwait
L_qready:
    ds_read_b128 v[152:155], v3
    s_waitcnt lgkmcnt(0)
    v_mfma_f32_16x16x32_bf16 v[160:163], v[8:11], v[152:155], 0
    v_mfma_f32_16x16x32_bf16 v[8:11], v[12:15], v[152:155], 0
    v_mfma_f32_16x16x32_bf16 v[12:15], v[16:19], v[152:155], 0
    v_mfma_f32_16x16x32_bf16 v[16:19], v[20:23], v[152:155], 0
    v_mfma_f32_16x16x32_bf16 v[20:23], v[24:27], v[152:155], 0
    v_mfma_f32_16x16x32_bf16 v[24:27], v[28:31], v[152:155], 0
    v_mfma_f32_16x16x32_bf16 v[28:31], v[32:35], v[152:155], 0
    v_mfma_f32_16x16x32_bf16 v[32:35], v[36:39], v[152:155], 0
    v_mfma_f32_16x16x32_bf16 v[36:39], v[40:43], v[152:155], 0
    v_mfma_f32_16x16x32_bf16 v[40:43], v[44:47], v[152:155], 0
    v_mfma_f32_16x16x32_bf16 v[44:47], v[48:51], v[152:155], 0
    v_mfma_f32_16x16x32_bf16 v[48:51], v[52:55], v[152:155], 0
    v_mfma_f32_16x16x32_bf16 v[52:55], v[56:59], v[152:155], 0
    v_mfma_f32_16x16x32_bf16 v[56:59], v[60:63], v[152:155], 0
    v_mfma_f32_16x16x32_bf16 v[60:63], v[64:67], v[152:155], 0
    v_mfma_f32_16x16x32_bf16 v[64:67], v[68:71], v[152:155], 0
    s_waitcnt vmcnt(7)
    buffer_load_dwordx4 v[104:107], v2, s[44:47], s73 offen offset:0 nt
    v_add_f32_dpp v136, v161, v160 row_ror:12 row_mask:0xf bank_mask:0xf
    v_add_f32_dpp v137, v9, v8 row_ror:12 row_mask:0xf bank_mask:0xf
    v_add_f32_dpp v138, v13, v12 row_ror:12 row_mask:0xf bank_mask:0xf
    v_add_f32_dpp v139, v17, v16 row_ror:12 row_mask:0xf bank_mask:0xf
    v_add_f32_dpp v140, v21, v20 row_ror:12 row_mask:0xf bank_mask:0xf
    v_add_f32_dpp v141, v25, v24 row_ror:12 row_mask:0xf bank_mask:0xf
    v_add_f32_dpp v142, v29, v28 row_ror:12 row_mask:0xf bank_mask:0xf
    v_add_f32_dpp v143, v33, v32 row_ror:12 row_mask:0xf bank_mask:0xf
    v_add_f32_dpp v144, v37, v36 row_ror:12 row_mask:0xf bank_mask:0xf
    v_add_f32_dpp v145, v41, v40 row_ror:12 row_mask:0xf bank_mask:0xf
    v_add_f32_dpp v146, v45, v44 row_ror:12 row_mask:0xf bank_mask:0xf
    v_add_f32_dpp v147, v49, v48 row_ror:12 row_mask:0xf bank_mask:0xf
    v_add_f32_dpp v148, v53, v52 row_ror:12 row_mask:0xf bank_mask:0xf
    v_add_f32_dpp v149, v57, v56 row_ror:12 row_mask:0xf bank_mask:0xf
    v_add_f32_dpp v150, v61, v60 row_ror:12 row_mask:0xf bank_mask:0xf
    v_add_f32_dpp v151, v65, v64 row_ror:12 row_mask:0xf bank_mask:0xf
    v_add_f32_dpp v136, v162, v136 row_ror:8 row_mask:0xf bank_mask:0xf
    v_add_f32_dpp v137, v10, v137 row_ror:8 row_mask:0xf bank_mask:0xf
    v_add_f32_dpp v138, v14, v138 row_ror:8 row_mask:0xf bank_mask:0xf
    v_add_f32_dpp v139, v18, v139 row_ror:8 row_mask:0xf bank_mask:0xf
    v_add_f32_dpp v140, v22, v140 row_ror:8 row_mask:0xf bank_mask:0xf
    v_add_f32_dpp v141, v26, v141 row_ror:8 row_mask:0xf bank_mask:0xf
    v_add_f32_dpp v142, v30, v142 row_ror:8 row_mask:0xf bank_mask:0xf
    v_add_f32_dpp v143, v34, v143 row_ror:8 row_mask:0xf bank_mask:0xf
    v_add_f32_dpp v144, v38, v144 row_ror:8 row_mask:0xf bank_mask:0xf
    v_add_f32_dpp v145, v42, v145 row_ror:8 row_mask:0xf bank_mask:0xf
    v_add_f32_dpp v146, v46, v146 row_ror:8 row_mask:0xf bank_mask:0xf
    v_add_f32_dpp v147, v50, v147 row_ror:8 row_mask:0xf bank_mask:0xf
    v_add_f32_dpp v148, v54, v148 row_ror:8 row_mask:0xf bank_mask:0xf
    v_add_f32_dpp v149, v58, v149 row_ror:8 row_mask:0xf bank_mask:0xf
    v_add_f32_dpp v150, v62, v150 row_ror:8 row_mask:0xf bank_mask:0xf
    v_add_f32_dpp v151, v66, v151 row_ror:8 row_mask:0xf bank_mask:0xf
    v_add_f32_dpp v136, v163, v136 row_ror:4 row_mask:0xf bank_mask:0xf
    v_add_f32_dpp v137, v11, v137 row_ror:4 row_mask:0xf bank_mask:0xf
    v_add_f32_dpp v138, v15, v138 row_ror:4 row_mask:0xf bank_mask:0xf
    v_add_f32_dpp v139, v19, v139 row_ror:4 row_mask:0xf bank_mask:0xf
    v_add_f32_dpp v140, v23, v140 row_ror:4 row_mask:0xf bank_mask:0xf
    v_add_f32_dpp v141, v27, v141 row_ror:4 row_mask:0xf bank_mask:0xf
    v_add_f32_dpp v142, v31, v142 row_ror:4 row_mask:0xf bank_mask:0xf
    v_add_f32_dpp v143, v35, v143 row_ror:4 row_mask:0xf bank_mask:0xf
    v_add_f32_dpp v144, v39, v144 row_ror:4 row_mask:0xf bank_mask:0xf
    v_add_f32_dpp v145, v43, v145 row_ror:4 row_mask:0xf bank_mask:0xf
    v_add_f32_dpp v146, v47, v146 row_ror:4 row_mask:0xf bank_mask:0xf
    v_add_f32_dpp v147, v51, v147 row_ror:4 row_mask:0xf bank_mask:0xf
    v_add_f32_dpp v148, v55, v148 row_ror:4 row_mask:0xf bank_mask:0xf
    v_add_f32_dpp v149, v59, v149 row_ror:4 row_mask:0xf bank_mask:0xf
    v_add_f32_dpp v150, v63, v150 row_ror:4 row_mask:0xf bank_mask:0xf
    v_add_f32_dpp v151, v67, v151 row_ror:4 row_mask:0xf bank_mask:0xf
    s_mov_b32 s8, 0x3db504f3
    s_mov_b32 s9, 0x3fb8aa3b
    v_cvt_pk_bf16_f32 v152, v136, v137
    v_lshlrev_b32 v136, 16, v152
    v_and_b32 v137, s69, v152
    v_cvt_pk_bf16_f32 v153, v138, v139
    v_lshlrev_b32 v138, 16, v153
    v_and_b32 v139, s69, v153
    v_cvt_pk_bf16_f32 v154, v140, v141
    v_lshlrev_b32 v140, 16, v154
    v_and_b32 v141, s69, v154
    v_cvt_pk_bf16_f32 v155, v142, v143
    v_lshlrev_b32 v142, 16, v155
    v_and_b32 v143, s69, v155
    v_cvt_pk_bf16_f32 v156, v144, v145
    v_lshlrev_b32 v144, 16, v156
    v_and_b32 v145, s69, v156
    v_cvt_pk_bf16_f32 v157, v146, v147
    v_lshlrev_b32 v146, 16, v157
    v_and_b32 v147, s69, v157
    v_cvt_pk_bf16_f32 v158, v148, v149
    v_lshlrev_b32 v148, 16, v158
    v_and_b32 v149, s69, v158
    v_cvt_pk_bf16_f32 v159, v150, v151
    v_lshlrev_b32 v150, 16, v159
    v_and_b32 v151, s69, v159
    v_pk_mul_f32 v[136:137], v[136:137], s[8:9] op_sel_hi:[1,0]
    v_pk_mul_f32 v[138:139], v[138:139], s[8:9] op_sel_hi:[1,0]
    v_pk_mul_f32 v[140:141], v[140:141], s[8:9] op_sel_hi:[1,0]
    v_pk_mul_f32 v[142:143], v[142:143], s[8:9] op_sel_hi:[1,0]
    v_pk_mul_f32 v[144:145], v[144:145], s[8:9] op_sel_hi:[1,0]
    v_pk_mul_f32 v[146:147], v[146:147], s[8:9] op_sel_hi:[1,0]
    v_pk_mul_f32 v[148:149], v[148:149], s[8:9] op_sel_hi:[1,0]
    v_pk_mul_f32 v[150:151], v[150:151], s[8:9] op_sel_hi:[1,0]
    s_waitcnt vmcnt(7)
    buffer_load_dwordx4 v[108:111], v2, s[44:47], s73 offen offset:1024 nt
    v_cvt_pk_bf16_f32 v152, v136, v137
    v_lshlrev_b32 v136, 16, v152
    v_and_b32 v137, s69, v152
    v_cvt_pk_bf16_f32 v153, v138, v139
    v_lshlrev_b32 v138, 16, v153
    v_and_b32 v139, s69, v153
    v_cvt_pk_bf16_f32 v154, v140, v141
    v_lshlrev_b32 v140, 16, v154
    v_and_b32 v141, s69, v154
    v_cvt_pk_bf16_f32 v155, v142, v143
    v_lshlrev_b32 v142, 16, v155
    v_and_b32 v143, s69, v155
    v_cvt_pk_bf16_f32 v156, v144, v145
    v_lshlrev_b32 v144, 16, v156
    v_and_b32 v145, s69, v156
    v_cvt_pk_bf16_f32 v157, v146, v147
    v_lshlrev_b32 v146, 16, v157
    v_and_b32 v147, s69, v157
    v_cvt_pk_bf16_f32 v158, v148, v149
    v_lshlrev_b32 v148, 16, v158
    v_and_b32 v149, s69, v158
    v_cvt_pk_bf16_f32 v159, v150, v151
    v_lshlrev_b32 v150, 16, v159
    v_and_b32 v151, s69, v159
    v_max3_f32 v152, v136, v137, v138
    v_max3_f32 v153, v139, v140, v141
    v_max3_f32 v154, v142, v143, v144
    v_max3_f32 v155, v145, v146, v147
    v_max3_f32 v156, v148, v149, v150
    v_max3_f32 v152, v152, v153, v151
    v_max3_f32 v154, v154, v155, v156
    v_max_f32 v4, v152, v154
    v_mov_b32 v152, v4
    s_nop 1
    v_permlane16_swap_b32 v152, v4
    v_max_f32 v4, v4, v152
    v_mov_b32 v152, v4
    s_nop 1
    v_permlane32_swap_b32 v152, v4
    v_max_f32 v4, v4, v152
    v_mul_f32 v4, s9, v4
    v_fma_f32 v136, v136, s9, -v4
    v_fma_f32 v137, v137, s9, -v4
    v_fma_f32 v138, v138, s9, -v4
    v_fma_f32 v139, v139, s9, -v4
    v_fma_f32 v140, v140, s9, -v4
    v_fma_f32 v141, v141, s9, -v4
    v_fma_f32 v142, v142, s9, -v4
    v_fma_f32 v143, v143, s9, -v4
    v_fma_f32 v144, v144, s9, -v4
    v_fma_f32 v145, v145, s9, -v4
    v_fma_f32 v146, v146, s9, -v4
    v_fma_f32 v147, v147, s9, -v4
    v_fma_f32 v148, v148, s9, -v4
    v_fma_f32 v149, v149, s9, -v4
    v_fma_f32 v150, v150, s9, -v4
    v_fma_f32 v151, v151, s9, -v4
    s_waitcnt vmcnt(7)
    buffer_load_dwordx4 v[112:115], v2, s[44:47], s73 offen offset:2048 nt
    v_exp_f32 v136, v136
    v_exp_f32 v137, v137
    v_exp_f32 v138, v138
    v_exp_f32 v139, v139
    v_exp_f32 v140, v140
    v_exp_f32 v141, v141
    v_exp_f32 v142, v142
    v_exp_f32 v143, v143
    v_exp_f32 v144, v144
    v_exp_f32 v145, v145
    v_exp_f32 v146, v146
    v_exp_f32 v147, v147
    v_exp_f32 v148, v148
    v_exp_f32 v149, v149
    v_exp_f32 v150, v150
    v_exp_f32 v151, v151
    v_pk_add_f32 v[152:153], v[136:137], v[138:139]
    v_pk_add_f32 v[154:155], v[140:141], v[142:143]
    v_pk_add_f32 v[156:157], v[144:145], v[146:147]
    v_pk_add_f32 v[158:159], v[148:149], v[150:151]
    v_pk_add_f32 v[152:153], v[152:153], v[154:155]
    v_pk_add_f32 v[156:157], v[156:157], v[158:159]
    v_pk_add_f32 v[152:153], v[152:153], v[156:157]
    v_add_f32 v5, v152, v153
    v_cvt_pk_bf16_f32 v160, v136, v137
    v_cvt_pk_bf16_f32 v161, v138, v139
    v_cvt_pk_bf16_f32 v162, v140, v141
    v_cvt_pk_bf16_f32 v163, v142, v143
    v_cvt_pk_bf16_f32 v164, v144, v145
    v_cvt_pk_bf16_f32 v165, v146, v147
    v_cvt_pk_bf16_f32 v166, v148, v149
    v_cvt_pk_bf16_f32 v167, v150, v151
    v_mov_b32 v152, v5
    s_nop 1
    v_permlane16_swap_b32 v152, v5
    v_add_f32 v5, v5, v152
    v_mov_b32 v152, v5
    s_nop 1
    v_permlane32_swap_b32 v152, v5
    v_add_f32 v5, v5, v152
    v_and_b32 v6, 15, v0
    v_lshlrev_b32 v6, 5, v6
    s_lshl_b32 s9, s3, 2
    s_add_u32 s9, s9, 8832
    v_add_u32 v6, s9, v6
    s_mov_b32 exec_lo, 0xf000f
    s_mov_b32 exec_hi, 0xf000f
    ds_write_b32 v6, v4
    ds_write_b32 v6, v5 offset:128
    s_mov_b64 exec, -1
    s_waitcnt vmcnt(7)
    buffer_load_dwordx4 v[116:119], v2, s[44:47], s73 offen offset:3072 nt
    s_waitcnt vmcnt(7)
    buffer_load_dwordx4 v[120:123], v2, s[44:47], s74 offen offset:0 nt
    s_waitcnt vmcnt(7)
    buffer_load_dwordx4 v[124:127], v2, s[44:47], s74 offen offset:1024 nt
    s_waitcnt vmcnt(7)
    buffer_load_dwordx4 v[128:131], v2, s[44:47], s74 offen offset:2048 nt
    s_waitcnt vmcnt(7)
    buffer_load_dwordx4 v[132:135], v2, s[44:47], s74 offen offset:3072 nt
    v_perm_b32 v40, v76, v72, s76
    v_perm_b32 v44, v76, v72, s77
    v_perm_b32 v48, v77, v73, s76
    v_perm_b32 v52, v77, v73, s77
    v_perm_b32 v56, v78, v74, s76
    v_perm_b32 v60, v78, v74, s77
    v_perm_b32 v64, v79, v75, s76
    v_perm_b32 v68, v79, v75, s77
    v_perm_b32 v41, v84, v80, s76
    v_perm_b32 v45, v84, v80, s77
    v_perm_b32 v49, v85, v81, s76
    v_perm_b32 v53, v85, v81, s77
    v_perm_b32 v57, v86, v82, s76
    v_perm_b32 v61, v86, v82, s77
    v_perm_b32 v65, v87, v83, s76
    v_perm_b32 v69, v87, v83, s77
    v_perm_b32 v42, v92, v88, s76
    v_perm_b32 v46, v92, v88, s77
    v_perm_b32 v50, v93, v89, s76
    v_perm_b32 v54, v93, v89, s77
    v_perm_b32 v58, v94, v90, s76
    v_perm_b32 v62, v94, v90, s77
    v_perm_b32 v66, v95, v91, s76
    v_perm_b32 v70, v95, v91, s77
    v_perm_b32 v43, v100, v96, s76
    v_perm_b32 v47, v100, v96, s77
    v_perm_b32 v51, v101, v97, s76
    v_perm_b32 v55, v101, v97, s77
    v_perm_b32 v59, v102, v98, s76
    v_perm_b32 v63, v102, v98, s77
    v_perm_b32 v67, v103, v99, s76
    v_perm_b32 v71, v103, v99, s77
    v_mfma_f32_16x16x32_bf16 v[8:11], v[40:43], v[160:163], 0
    v_mfma_f32_16x16x32_bf16 v[12:15], v[44:47], v[160:163], 0
    v_mfma_f32_16x16x32_bf16 v[16:19], v[48:51], v[160:163], 0
    v_mfma_f32_16x16x32_bf16 v[20:23], v[52:55], v[160:163], 0
    v_mfma_f32_16x16x32_bf16 v[24:27], v[56:59], v[160:163], 0
    v_mfma_f32_16x16x32_bf16 v[28:31], v[60:63], v[160:163], 0
    v_mfma_f32_16x16x32_bf16 v[32:35], v[64:67], v[160:163], 0
    v_mfma_f32_16x16x32_bf16 v[36:39], v[68:71], v[160:163], 0
    s_waitcnt lgkmcnt(0)
    s_barrier
    s_lshr_b32 s10, s3, 1
    s_lshl_b32 s9, s10, 5
    s_add_u32 s9, s9, 8832
    v_mov_b32 v6, s9
    ds_read_b128 v[136:139], v6
    ds_read_b128 v[140:143], v6 offset:16
    ds_read_b128 v[144:147], v6 offset:128
    ds_read_b128 v[148:151], v6 offset:144
    s_waitcnt lgkmcnt(2)
    v_max3_f32 v152, v136, v137, v138
    v_max3_f32 v153, v139, v140, v141
    v_max3_f32 v152, v152, v142, v143
    v_max_f32 v152, v152, v153
    v_sub_f32 v136, v136, v152
    v_sub_f32 v137, v137, v152
    v_sub_f32 v138, v138, v152
    v_sub_f32 v139, v139, v152
    v_sub_f32 v140, v140, v152
    v_sub_f32 v141, v141, v152
    v_sub_f32 v142, v142, v152
    v_sub_f32 v143, v143, v152
    v_exp_f32 v136, v136
    v_exp_f32 v137, v137
    v_exp_f32 v138, v138
    v_exp_f32 v139, v139
    v_exp_f32 v140, v140
    v_exp_f32 v141, v141
    v_exp_f32 v142, v142
    v_exp_f32 v143, v143
    s_waitcnt lgkmcnt(0)
    v_mul_f32 v153, v136, v144
    v_fmac_f32 v153, v137, v145
    v_fmac_f32 v153, v138, v146
    v_fmac_f32 v153, v139, v147
    v_fmac_f32 v153, v140, v148
    v_fmac_f32 v153, v141, v149
    v_fmac_f32 v153, v142, v150
    v_fmac_f32 v153, v143, v151
    v_rcp_f32 v154, v153
    v_log_f32 v155, v153
    v_mul_f32 v136, v154, v136
    v_mul_f32 v137, v154, v137
    v_mul_f32 v138, v154, v138
    v_mul_f32 v139, v154, v139
    v_mul_f32 v140, v154, v140
    v_mul_f32 v141, v154, v141
    v_mul_f32 v142, v154, v142
    v_mul_f32 v143, v154, v143
    v_add_f32 v158, v155, v152
    v_mov_b32 v159, s68
    v_and_b32 v6, 15, v0
    v_lshrrev_b32 v7, 4, v0
    v_mul_u32_u24 v1, 640, v6
    v_lshl_add_u32 v1, v7, 4, v1
    s_mul_i32 s8, s3, 2560
    s_add_u32 s8, s8, 74752
    v_add_u32 v1, s8, v1
    s_and_b32 s11, s3, 1
    s_lshl_b32 s11, s11, 6
    v_lshlrev_b32 v3, 2, v6
    v_add3_u32 v3, v3, v7, s11
    v_and_b32 v2, 7, v3
    v_mul_u32_u24 v2, 80, v2
    v_lshrrev_b32 v4, 5, v3
    v_lshl_add_u32 v2, v4, 4, v2
    v_bfe_u32 v4, v3, 3, 2
    v_lshl_add_u32 v2, v4, 2, v2
    s_mul_i32 s8, s10, 640
    s_add_u32 s8, s8, 74752
    v_add_u32 v2, s8, v2
    v_lshlrev_b32 v3, 4, v0
    s_lshl_b32 s8, s2, 12
    s_lshl_b32 s9, s10, 10
    s_add_u32 s8, s8, s9
    s_lshl_b32 s9, s11, 2
    s_add_u32 s8, s8, s9
    s_add_u32 s13, s8, 1049088
    s_add_u32 s63, s8, 5243392
    s_cmp_eq_u32 s62, 0
    s_cbranch_scc1 L_prefin
    s_lshr_b32 s12, s60, 1
    s_lshl_b32 s8, s10, 6
    s_add_u32 s8, s8, s4
    v_lshrrev_b32 v4, 3, v0
    v_lshl_add_u32 v4, v4, 3, s8
    v_and_b32 v6, 7, v0
    s_and_b32 s9, s3, 1
    s_lshl_b32 s9, s9, 3
    v_add_u32 v6, s9, v6
    v_lshlrev_b32 v4, 12, v4
    v_lshl_add_u32 v4, v6, 4, v4
    s_lshr_b32 s8, s12, 1
    s_lshl_b32 s8, s8, 10
    s_and_b32 s9, s12, 1
    s_lshl_b32 s9, s9, 8
    s_add_u32 s8, s8, s9
    s_add_u32 s15, s8, 1049088
    s_add_u32 s71, s8, 5243392
    s_mul_i32 s8, s10, 192
    s_add_u32 s8, s8, 8064
    v_lshl_add_u32 v6, v6, 3, s8
    v_bfe_u32 v5, v0, 2, 2
    v_lshl_add_u32 v5, v7, 3, v5
    v_lshlrev_b32 v5, 9, v5
    v_and_b32 v144, 3, v0
    v_lshl_add_u32 v5, v144, 3, v5
    s_lshl_b32 s8, s3, 6
    s_add_u32 s8, s8, 41984
    v_add_u32 v5, s8, v5
    v_bfe_u32 v145, v0, 2, 1
    v_and_b32 v146, 1, v0
    v_lshl_add_u32 v145, v145, 1, v146
    v_mul_u32_u24 v145, 192, v145
    v_lshl_add_u32 v7, v7, 4, v145
    v_add_u32 v7, 8064, v7
    s_and_b32 s8, s60, 1
    s_lshl_b32 s8, s8, 6
    s_lshl_b32 s9, s3, 3
    s_add_u32 s8, s8, s9
    s_lshl_b32 s8, s8, 14
    s_lshl_b32 s9, s4, 1
    s_lshr_b32 s14, s12, 2
    s_add_u32 s9, s9, s14
    s_lshl_b32 s9, s9, 10
    s_add_u32 s8, s8, s9
    s_and_b32 s9, s12, 3
    s_lshl_b32 s9, s9, 7
    s_add_u32 s8, s8, s9
    s_add_u32 s14, s8, 2097664
    v_lshrrev_b32 v145, 5, v0
    v_bfe_u32 v146, v0, 2, 2
    v_lshl_add_u32 v145, v145, 2, v146
    v_lshlrev_b32 v145, 14, v145
    v_lshl_add_u32 v144, v144, 4, v145
    v_bfe_u32 v146, v0, 4, 1
    v_lshl_add_u32 v144, v146, 6, v144
    s_branch L_predone
L_prefin:
    s_lshl_b32 s12, s4, 4
    s_add_u32 s12, s12, s61
    v_lshrrev_b32 v4, 5, v0
    v_lshlrev_b32 v4, 10, v4
    v_and_b32 v5, 31, v0
    v_lshl_add_u32 v4, v5, 4, v4
    s_lshl_b32 s8, s12, 14
    s_lshl_b32 s9, s3, 11
    s_add_u32 s8, s8, s9
    s_add_u32 s14, s8, 2097664
    s_lshl_b32 s9, s3, 6
    s_add_u32 s9, s9, 95232
    v_lshl_add_u32 v5, v0, 3, s9
    v_lshlrev_b32 v6, 3, v0
    v_add_u32 v6, 95232, v6
    v_and_b32 v7, 3, v0
    s_lshl_b32 s8, s12, 2
    v_add_u32 v7, s8, v7
    v_lshlrev_b32 v7, 1, v7
    v_bfe_u32 v144, v0, 2, 1
    v_lshl_add_u32 v7, v144, 11, v7
L_predone:
    s_waitcnt vmcnt(6)
    v_perm_b32 v40, v108, v104, s76
    v_perm_b32 v44, v108, v104, s77
    v_perm_b32 v48, v109, v105, s76
    v_perm_b32 v52, v109, v105, s77
    v_perm_b32 v56, v110, v106, s76
    v_perm_b32 v60, v110, v106, s77
    v_perm_b32 v64, v111, v107, s76
    v_perm_b32 v68, v111, v107, s77
    s_waitcnt vmcnt(4)
    v_perm_b32 v41, v116, v112, s76
    v_perm_b32 v45, v116, v112, s77
    v_perm_b32 v49, v117, v113, s76
    v_perm_b32 v53, v117, v113, s77
    v_perm_b32 v57, v118, v114, s76
    v_perm_b32 v61, v118, v114, s77
    v_perm_b32 v65, v119, v115, s76
    v_perm_b32 v69, v119, v115, s77
    s_waitcnt vmcnt(2)
    v_perm_b32 v42, v124, v120, s76
    v_perm_b32 v46, v124, v120, s77
    v_perm_b32 v50, v125, v121, s76
    v_perm_b32 v54, v125, v121, s77
    v_perm_b32 v58, v126, v122, s76
    v_perm_b32 v62, v126, v122, s77
    v_perm_b32 v66, v127, v123, s76
    v_perm_b32 v70, v127, v123, s77
    s_waitcnt vmcnt(0)
    v_perm_b32 v43, v132, v128, s76
    v_perm_b32 v47, v132, v128, s77
    v_perm_b32 v51, v133, v129, s76
    v_perm_b32 v55, v133, v129, s77
    v_perm_b32 v59, v134, v130, s76
    v_perm_b32 v63, v134, v130, s77
    v_perm_b32 v67, v135, v131, s76
    v_perm_b32 v71, v135, v131, s77
    v_mfma_f32_16x16x32_bf16 v[8:11], v[40:43], v[164:167], v[8:11]
    v_mfma_f32_16x16x32_bf16 v[12:15], v[44:47], v[164:167], v[12:15]
    v_mfma_f32_16x16x32_bf16 v[16:19], v[48:51], v[164:167], v[16:19]
    v_mfma_f32_16x16x32_bf16 v[20:23], v[52:55], v[164:167], v[20:23]
    v_mfma_f32_16x16x32_bf16 v[24:27], v[56:59], v[164:167], v[24:27]
    v_mfma_f32_16x16x32_bf16 v[28:31], v[60:63], v[164:167], v[28:31]
    v_mfma_f32_16x16x32_bf16 v[32:35], v[64:67], v[164:167], v[32:35]
    v_mfma_f32_16x16x32_bf16 v[36:39], v[68:71], v[164:167], v[36:39]
    s_mov_b32 exec_lo, 0xf000f
    s_mov_b32 exec_hi, 0xf000f
    ds_write_b128 v1, v[8:11] offset:0
    ds_write_b128 v1, v[12:15] offset:80
    ds_write_b128 v1, v[16:19] offset:160
    ds_write_b128 v1, v[20:23] offset:240
    ds_write_b128 v1, v[24:27] offset:320
    ds_write_b128 v1, v[28:31] offset:400
    ds_write_b128 v1, v[32:35] offset:480
    ds_write_b128 v1, v[36:39] offset:560
    s_mov_b64 exec, -1
    s_waitcnt lgkmcnt(0)
    s_barrier
    ds_read_b32 v24, v2 offset:0
    ds_read_b32 v25, v2 offset:2560
    ds_read_b32 v26, v2 offset:5120
    ds_read_b32 v27, v2 offset:7680
    ds_read_b32 v28, v2 offset:10240
    ds_read_b32 v29, v2 offset:12800
    ds_read_b32 v30, v2 offset:15360
    ds_read_b32 v31, v2 offset:17920
    s_waitcnt lgkmcnt(4)
    v_mul_f32 v34, v136, v24
    v_mul_f32 v35, v137, v25
    v_fmac_f32 v34, v138, v26
    v_fmac_f32 v35, v139, v27
    s_waitcnt lgkmcnt(0)
    v_fmac_f32 v34, v140, v28
    v_fmac_f32 v35, v141, v29
    v_fmac_f32 v34, v142, v30
    v_fmac_f32 v35, v143, v31
    v_add_f32 v34, v34, v35
    v_mov_b32 v35, v34
    s_nop 1
    v_permlane16_swap_b32 v34, v35
    v_cvt_pk_bf16_f32 v156, v34, v35
    v_mov_b32 v157, v156
    s_nop 1
    v_permlane32_swap_b32 v156, v157
    s_mov_b32 exec_lo, 0xffff
    s_mov_b32 exec_hi, 0x0
    buffer_store_dwordx4 v[156:159], v3, s[64:67], s63 offen
    s_cmp_eq_u32 s62, 0
    s_cbranch_scc1 L_notw
    s_mov_b64 exec, -1
    buffer_load_dwordx4 v[8:11], v4, s[64:67], s71 offen sc1
    v_mov_b32 v22, 12
    s_mov_b32 s75, 0
L_wland:
    ds_read_b32 v23, v22
    s_add_u32 s75, s75, 1
    s_waitcnt lgkmcnt(0)
    v_readfirstlane_b32 s8, v23
    s_nop 0
    s_cmp_ge_u32 s8, 1
    s_cbranch_scc1 L_wland_ok
    s_cmp_gt_u32 s75, 2097152
    s_cbranch_scc1 L_wland_ok
    s_sleep 2
    s_branch L_wland
L_wland_ok:
    ds_read_b64_tr_b16 v[40:41], v5 offset:0
    ds_read_b64_tr_b16 v[42:43], v5 offset:2048
    ds_read_b64_tr_b16 v[44:45], v5 offset:32
    ds_read_b64_tr_b16 v[46:47], v5 offset:2080
    ds_read_b64_tr_b16 v[48:49], v5 offset:16384
    ds_read_b64_tr_b16 v[50:51], v5 offset:18432
    ds_read_b64_tr_b16 v[52:53], v5 offset:16416
    ds_read_b64_tr_b16 v[54:55], v5 offset:18464
    v_mov_b32 v25, s68
    v_mov_b32 v27, s68
    s_mov_b32 s75, 0
    s_branch L_x1_chk
L_x1:
    s_cmp_lg_u32 s75, 3
    s_cbranch_scc1 L_x1_nog
    s_mov_b32 exec_lo, 0xffff
    s_mov_b32 exec_hi, 0x0
    buffer_store_dwordx4 v[156:159], v3, s[64:67], s13 offen sc1
L_x1_nog:
    s_cmp_eq_u64 vcc, -1
    s_cbranch_scc0 L_x1_go
    s_sleep 2
L_x1_go:
    s_and_b32 s9, s75, 1
    s_cmp_ge_u32 s75, 24
    s_cselect_b32 s9, s9, 0
    s_mov_b64 exec, vcc
    s_cmp_eq_u32 s9, 1
    s_cbranch_scc1 L_x1_g
    buffer_load_dwordx4 v[8:11], v4, s[64:67], s71 offen sc1
    s_branch L_x1_chk
L_x1_g:
    buffer_load_dwordx4 v[8:11], v4, s[64:67], s15 offen sc1
L_x1_chk:
    s_add_u32 s75, s75, 1
    s_waitcnt vmcnt(0)
    v_cmp_ne_u32 vcc, s68, v11
    s_cmp_gt_u32 s75, 262144
    s_cbranch_scc1 L_x1_done
    s_cbranch_vccnz L_x1
L_x1_done:
    s_mov_b64 exec, -1
    v_max_f32_dpp v14, v10, v10 row_ror:8 row_mask:0xf bank_mask:0xf
    v_lshlrev_b32 v16, 16, v8
    v_and_b32 v17, s69, v8
    v_mov_b32 v15, v14
    v_lshlrev_b32 v18, 16, v9
    v_and_b32 v19, s69, v9
    v_permlane16_swap_b32 v15, v14
    v_max_f32 v14, v14, v15
    v_mov_b32 v15, v14
    s_nop 1
    v_permlane32_swap_b32 v15, v14
    v_max_f32 v14, v14, v15
    v_sub_f32 v12, v10, v14
    v_exp_f32 v12, v12
    v_mov_b32 v21, 0
    v_pk_mul_f32 v[16:17], v[16:17], v[12:13] op_sel_hi:[1,0]
    v_pk_mul_f32 v[18:19], v[18:19], v[12:13] op_sel_hi:[1,0]
    v_mov_b32 v20, v12
    v_add_f32_dpp v16, v16, v16 row_ror:8 row_mask:0xf bank_mask:0xf
    v_add_f32_dpp v17, v17, v17 row_ror:8 row_mask:0xf bank_mask:0xf
    v_add_f32_dpp v18, v18, v18 row_ror:8 row_mask:0xf bank_mask:0xf
    v_add_f32_dpp v19, v19, v19 row_ror:8 row_mask:0xf bank_mask:0xf
    v_add_f32_dpp v20, v20, v20 row_ror:8 row_mask:0xf bank_mask:0xf
    v_mov_b64 v[30:31], v[16:17]
    v_mov_b64 v[32:33], v[18:19]
    v_mov_b64 v[34:35], v[20:21]
    v_permlane16_swap_b32 v30, v16
    v_permlane16_swap_b32 v31, v17
    v_permlane16_swap_b32 v32, v18
    v_permlane16_swap_b32 v33, v19
    v_permlane16_swap_b32 v34, v20
    v_pk_add_f32 v[16:17], v[16:17], v[30:31]
    v_pk_add_f32 v[18:19], v[18:19], v[32:33]
    v_pk_add_f32 v[20:21], v[20:21], v[34:35]
    v_mov_b64 v[30:31], v[16:17]
    v_mov_b64 v[32:33], v[18:19]
    v_mov_b64 v[34:35], v[20:21]
    v_permlane32_swap_b32 v30, v16
    v_permlane32_swap_b32 v31, v17
    v_permlane32_swap_b32 v32, v18
    v_permlane32_swap_b32 v33, v19
    v_permlane32_swap_b32 v34, v20
    v_pk_add_f32 v[16:17], v[16:17], v[30:31]
    v_pk_add_f32 v[18:19], v[18:19], v[32:33]
    v_pk_add_f32 v[20:21], v[20:21], v[34:35]
    v_rcp_f32 v12, v20
    s_nop 0
    v_pk_mul_f32 v[16:17], v[16:17], v[12:13] op_sel_hi:[1,0]
    v_pk_mul_f32 v[18:19], v[18:19], v[12:13] op_sel_hi:[1,0]
    v_cvt_pk_bf16_f32 v8, v16, v17
    v_cvt_pk_bf16_f32 v9, v18, v19
    s_mov_b32 exec_lo, 0xff
    s_mov_b32 exec_hi, 0x0
    ds_write_b64 v6, v[8:9]
    s_cmp_gt_u32 s75, 3
    s_cbranch_scc1 L_x1_pub
    s_mov_b32 exec_lo, 0xffff
    s_mov_b32 exec_hi, 0x0
    buffer_store_dwordx4 v[156:159], v3, s[64:67], s13 offen sc1
L_x1_pub:
    s_mov_b64 exec, -1
    s_waitcnt lgkmcnt(0)
    s_barrier
    ds_read_b128 v[8:11], v7
    ds_read_b128 v[12:15], v7 offset:64
    s_waitcnt lgkmcnt(1)
    v_mfma_f32_16x16x32_bf16 v[28:31], v[8:11], v[40:43], 0
    v_mfma_f32_16x16x32_bf16 v[32:35], v[8:11], v[44:47], 0
    s_waitcnt lgkmcnt(0)
    v_mfma_f32_16x16x32_bf16 v[28:31], v[12:15], v[48:51], v[28:31]
    v_mfma_f32_16x16x32_bf16 v[32:35], v[12:15], v[52:55], v[32:35]
    s_nop 7
    v_cndmask_b32 v24, v28, v32, s[58:59]
    v_cndmask_b32 v26, v29, v33, s[58:59]
    buffer_store_dwordx4 v[24:27], v144, s[64:67], s14 offen sc1
    s_branch L_fin
L_notw:
    buffer_store_dwordx4 v[156:159], v3, s[64:67], s13 offen sc1
    s_mov_b64 exec, -1
    s_cmp_lg_u32 s3, 0
    s_cbranch_scc1 L_noy
    s_mov_b32 s40, s16
    s_and_b32 s41, s17, 0xffff
    s_mov_b32 s42, 0x1000
    s_mov_b32 s43, 0x20000
    s_mov_b32 s44, s34
    s_and_b32 s45, s35, 0xffff
    s_mov_b32 s46, 0x1000
    s_mov_b32 s47, 0x20000
    buffer_load_ushort v2, v7, s[40:43], 0 offen
    buffer_load_ushort v3, v7, s[40:43], 0 offen offset:1024
    s_lshl_b32 s8, s12, 11
    s_add_u32 s8, s8, 524800
    v_mov_b32 v8, 0
    v_mov_b32 v10, 0
    v_mov_b32 v9, s68
    v_mov_b32 v11, s68
    s_mov_b32 s75, 0
L_y:
    s_mov_b32 exec_lo, 0xffffffff
    s_mov_b32 exec_hi, 0xffffff
    buffer_load_dwordx4 v[8:11], v4, s[64:67], s8 offen sc1
    s_mov_b64 exec, -1
    s_add_u32 s75, s75, 1
    s_waitcnt vmcnt(0)
    v_xor_b32 v14, s68, v9
    v_bitop3_b32 v14, v11, s68, v14 bitop3:0xbe
    v_cmp_ne_u32 vcc, 0, v14
    s_cmp_gt_u32 s75, 262144
    s_cbranch_scc1 L_ydone
    s_cbranch_vccz L_ydone
    s_sleep 2
    s_branch L_y
L_ydone:
    v_add_f32_dpp v8, v8, v8 row_ror:8 row_mask:0xf bank_mask:0xf
    v_add_f32_dpp v10, v10, v10 row_ror:8 row_mask:0xf bank_mask:0xf
    v_mov_b32 v12, v8
    v_mov_b32 v13, v10
    s_nop 0
    v_permlane16_swap_b32 v12, v8
    v_permlane16_swap_b32 v13, v10
    v_add_f32 v8, v8, v12
    v_add_f32 v10, v10, v13
    v_mov_b32 v12, v8
    v_mov_b32 v13, v10
    s_nop 0
    v_permlane32_swap_b32 v12, v8
    v_permlane32_swap_b32 v13, v10
    v_add_f32 v8, v8, v12
    v_add_f32 v10, v10, v13
    v_cvt_pk_bf16_f32 v12, v8, v10
    v_lshlrev_b32 v8, 16, v12
    v_and_b32 v10, s69, v12
    s_mov_b32 s70, 0x3fb8aa3b
    v_mul_f32 v9, s70, v8
    v_mul_f32 v11, s70, v10
    v_exp_f32 v9, -v9
    v_exp_f32 v11, -v11
    v_add_f32 v9, 1.0, v9
    v_add_f32 v11, 1.0, v11
    v_rcp_f32 v9, v9
    v_rcp_f32 v11, v11
    v_mul_f32 v8, v8, v9
    v_mul_f32 v10, v10, v11
    v_cvt_pk_bf16_f32 v12, v8, v10
    v_lshlrev_b32 v8, 16, v12
    v_and_b32 v10, s69, v12
    v_lshlrev_b32 v2, 16, v2
    v_lshlrev_b32 v3, 16, v3
L_noy:
    buffer_load_dwordx4 v[16:19], v4, s[64:67], s14 offen sc1
    s_mov_b32 s75, 0
    s_branch L_s2_chk
L_s2:
    s_cmp_eq_u64 vcc, -1
    s_cbranch_scc0 L_s2_go
    s_sleep 6
L_s2_go:
    s_mov_b64 exec, vcc
    buffer_load_dwordx4 v[16:19], v4, s[64:67], s14 offen sc1
L_s2_chk:
    s_add_u32 s75, s75, 1
    s_waitcnt vmcnt(0)
    v_xor_b32 v14, s68, v17
    v_bitop3_b32 v14, v19, s68, v14 bitop3:0xbe
    v_cmp_ne_u32 vcc, 0, v14
    s_cmp_gt_u32 s75, 262144
    s_cbranch_scc1 L_s2_done
    s_cbranch_vccnz L_s2
L_s2_done:
    s_mov_b64 exec, -1
    v_add_f32_dpp v16, v16, v16 row_ror:8 row_mask:0xf bank_mask:0xf
    v_add_f32_dpp v18, v18, v18 row_ror:8 row_mask:0xf bank_mask:0xf
    v_mov_b32 v12, v16
    v_mov_b32 v13, v18
    s_nop 0
    v_permlane16_swap_b32 v12, v16
    v_permlane16_swap_b32 v13, v18
    v_add_f32 v16, v16, v12
    v_add_f32 v18, v18, v13
    v_mov_b32 v12, v16
    v_mov_b32 v13, v18
    s_nop 0
    v_permlane32_swap_b32 v12, v16
    v_permlane32_swap_b32 v13, v18
    v_add_f32 v16, v16, v12
    v_add_f32 v18, v18, v13
    v_mov_b32 v17, v18
    s_mov_b32 exec_lo, 0xff
    s_mov_b32 exec_hi, 0x0
    ds_write_b64 v5, v[16:17]
    s_mov_b64 exec, -1
    s_waitcnt lgkmcnt(0)
    s_barrier
    s_cmp_lg_u32 s3, 0
    s_cbranch_scc1 L_fin
    ds_read_b64 v[16:17], v6
    s_waitcnt lgkmcnt(0)
    v_add_f32_dpp v16, v16, v16 row_ror:8 row_mask:0xf bank_mask:0xf
    v_add_f32_dpp v17, v17, v17 row_ror:8 row_mask:0xf bank_mask:0xf
    v_mov_b32 v12, v16
    v_mov_b32 v13, v17
    s_nop 0
    v_permlane16_swap_b32 v12, v16
    v_permlane16_swap_b32 v13, v17
    v_add_f32 v16, v16, v12
    v_add_f32 v17, v17, v13
    v_mov_b32 v12, v16
    v_mov_b32 v13, v17
    s_nop 0
    v_permlane32_swap_b32 v12, v16
    v_permlane32_swap_b32 v13, v17
    v_add_f32 v16, v16, v12
    v_add_f32 v17, v17, v13
    v_cvt_pk_bf16_f32 v12, v16, v17
    v_lshlrev_b32 v16, 16, v12
    v_and_b32 v17, s69, v12
    v_mul_f32 v16, v16, v8
    v_mul_f32 v17, v17, v10
    v_cvt_pk_bf16_f32 v12, v16, v17
    v_lshlrev_b32 v16, 16, v12
    v_and_b32 v17, s69, v12
    v_add_f32 v16, v16, v2
    v_add_f32 v17, v17, v3
    v_cvt_pk_bf16_f32 v12, v16, v17
    s_mov_b32 exec_lo, 0xff
    s_mov_b32 exec_hi, 0x0
    buffer_store_short v12, v7, s[44:47], 0 offen
    buffer_store_short_d16_hi v12, v7, s[44:47], 0 offen offset:1024
    s_cmp_lg_u32 s12, 0
    s_cbranch_scc1 L_noepoch
    s_mov_b32 exec_lo, 0x1
    s_mov_b32 exec_hi, 0x0
    v_mov_b32 v13, s68
    v_mov_b32 v14, 0
    buffer_store_dword v13, v14, s[64:67], 0 offen offset:512 sc1
L_noepoch:
    s_mov_b64 exec, -1
    s_branch L_fin
L_service:
    s_setprio 3
    v_mov_b32 v8, 0
    v_mov_b32 v9, 0
    v_mov_b32 v10, 0
    v_mov_b32 v11, 0
    ds_write_b128 v8, v[8:11]
    ds_write_b128 v8, v[8:11] offset:16
    v_lshlrev_b32 v1, 4, v0
    s_sub_u32 s8, s5, 16
    s_mul_i32 s9, s4, 14
    s_add_u32 s9, s9, s8
    s_cmp_ge_u32 s9, 56
    s_cselect_b32 s15, 1, 0
    s_cselect_b32 s10, 56, 0
    s_sub_u32 s14, s9, s10
    s_cmp_lt_u32 s5, 16
    s_cselect_b32 s14, s5, s14
    s_lshr_b32 s14, s14, 1
    s_waitcnt lgkmcnt(0)
    s_cmp_eq_u32 s15, 1
    s_cselect_b32 s10, s30, s28
    s_cselect_b32 s11, s31, s29
    s_cmp_lt_u32 s5, 16
    s_cselect_b32 s44, s22, s10
    s_cselect_b32 s11, s23, s11
    s_and_b32 s45, s11, 0xffff
    s_cmp_lt_u32 s5, 16
    s_cselect_b32 s46, 0x400000, 0
    s_cselect_b32 s10, 0, 0x1c0000
    s_add_u32 s46, s46, s10
    s_mov_b32 s47, 0x20000
    s_cmp_lt_u32 s5, 16
    s_cselect_b32 s13, 0x2000, 0
    s_cselect_b32 s10, 0, 3584
    s_add_u32 s13, s13, s10
    s_lshl_b32 s10, s4, 10
    s_cmp_lt_u32 s5, 16
    s_cselect_b32 s10, s10, 0
    s_lshl_b32 s11, s14, 7
    s_add_u32 s12, s10, s11
    s_and_b32 s10, s5, 1
    s_lshl_b32 s10, s10, 8
    s_mul_i32 s10, s10, s13
    s_add_u32 s12, s12, s10
    v_lshrrev_b32 v4, 3, v0
    v_mul_lo_u32 v2, s13, v4
    v_bfe_u32 v5, v0, 4, 1
    v_lshlrev_b32 v5, 1, v5
    v_and_b32 v4, 7, v0
    v_xor_b32 v4, v4, v5
    v_xor_b32 v5, 4, v4
    v_lshl_add_u32 v3, v5, 4, v2
    v_lshl_add_u32 v2, v4, 4, v2
    s_mov_b32 s40, s16
    s_and_b32 s41, s17, 0xffff
    s_mov_b32 s42, 0x1000
    s_mov_b32 s43, 0x20000
    s_mov_b32 s64, s38
    s_and_b32 s65, s39, 0xffff
    s_mov_b32 s66, 0x800000
    s_mov_b32 s67, 0x20000
    v_mov_b32 v5, 0
    buffer_load_dword v6, v5, s[64:67], 0 offen offset:512
    s_cmp_ge_u32 s5, 30
    s_cbranch_scc1 L_noearly
    buffer_load_dwordx4 v[8:11], v1, s[40:43], 0 offen offset:0
    buffer_load_dwordx4 v[12:15], v1, s[40:43], 0 offen offset:1024
    buffer_load_dwordx4 v[16:19], v1, s[40:43], 0 offen offset:2048
    buffer_load_dwordx4 v[20:23], v1, s[40:43], 0 offen offset:3072
    s_lshl_b32 s13, s13, 3
    s_mov_b32 m0, 9216
    s_nop 0
    buffer_load_dwordx4 v2, s[44:47], s12 offen nt lds
    s_mov_b32 m0, 10240
    s_add_u32 s12, s12, s13
    buffer_load_dwordx4 v3, s[44:47], s12 offen nt lds
    s_mov_b32 m0, 11264
    s_add_u32 s12, s12, s13
    buffer_load_dwordx4 v2, s[44:47], s12 offen nt lds
    s_mov_b32 m0, 12288
    s_add_u32 s12, s12, s13
    buffer_load_dwordx4 v3, s[44:47], s12 offen nt lds
    s_mov_b32 m0, 13312
    s_add_u32 s12, s12, s13
    buffer_load_dwordx4 v2, s[44:47], s12 offen nt lds
    s_mov_b32 m0, 14336
    s_add_u32 s12, s12, s13
    buffer_load_dwordx4 v3, s[44:47], s12 offen nt lds
    s_mov_b32 m0, 15360
    s_add_u32 s12, s12, s13
    buffer_load_dwordx4 v2, s[44:47], s12 offen nt lds
    s_mov_b32 m0, 16384
    s_add_u32 s12, s12, s13
    buffer_load_dwordx4 v3, s[44:47], s12 offen nt lds
    s_mov_b32 m0, 17408
    s_add_u32 s12, s12, s13
    buffer_load_dwordx4 v2, s[44:47], s12 offen nt lds
    s_mov_b32 m0, 18432
    s_add_u32 s12, s12, s13
    buffer_load_dwordx4 v3, s[44:47], s12 offen nt lds
    s_mov_b32 m0, 19456
    s_add_u32 s12, s12, s13
    buffer_load_dwordx4 v2, s[44:47], s12 offen nt lds
    s_mov_b32 m0, 20480
    s_add_u32 s12, s12, s13
    buffer_load_dwordx4 v3, s[44:47], s12 offen nt lds
    s_mov_b32 m0, 21504
    s_add_u32 s12, s12, s13
    buffer_load_dwordx4 v2, s[44:47], s12 offen nt lds
    s_mov_b32 m0, 22528
    s_add_u32 s12, s12, s13
    buffer_load_dwordx4 v3, s[44:47], s12 offen nt lds
    s_mov_b32 m0, 23552
    s_add_u32 s12, s12, s13
    buffer_load_dwordx4 v2, s[44:47], s12 offen nt lds
    s_mov_b32 m0, 24576
    s_add_u32 s12, s12, s13
    buffer_load_dwordx4 v3, s[44:47], s12 offen nt lds
    s_mov_b32 m0, 25600
    s_add_u32 s12, s12, s13
    buffer_load_dwordx4 v2, s[44:47], s12 offen nt lds
    s_mov_b32 m0, 26624
    s_add_u32 s12, s12, s13
    buffer_load_dwordx4 v3, s[44:47], s12 offen nt lds
    s_mov_b32 m0, 27648
    s_add_u32 s12, s12, s13
    buffer_load_dwordx4 v2, s[44:47], s12 offen nt lds
    s_mov_b32 m0, 28672
    s_add_u32 s12, s12, s13
    buffer_load_dwordx4 v3, s[44:47], s12 offen nt lds
    s_mov_b32 m0, 29696
    s_add_u32 s12, s12, s13
    buffer_load_dwordx4 v2, s[44:47], s12 offen nt lds
    s_mov_b32 m0, 30720
    s_add_u32 s12, s12, s13
    buffer_load_dwordx4 v3, s[44:47], s12 offen nt lds
    s_mov_b32 m0, 31744
    s_add_u32 s12, s12, s13
    buffer_load_dwordx4 v2, s[44:47], s12 offen nt lds
    s_mov_b32 m0, 32768
    s_add_u32 s12, s12, s13
    buffer_load_dwordx4 v3, s[44:47], s12 offen nt lds
    s_mov_b32 m0, 33792
    s_add_u32 s12, s12, s13
    buffer_load_dwordx4 v2, s[44:47], s12 offen nt lds
    s_mov_b32 m0, 34816
    s_add_u32 s12, s12, s13
    buffer_load_dwordx4 v3, s[44:47], s12 offen nt lds
    s_mov_b32 m0, 35840
    s_add_u32 s12, s12, s13
    buffer_load_dwordx4 v2, s[44:47], s12 offen nt lds
    s_mov_b32 m0, 36864
    s_add_u32 s12, s12, s13
    buffer_load_dwordx4 v3, s[44:47], s12 offen nt lds
    s_mov_b32 m0, 37888
    s_add_u32 s12, s12, s13
    buffer_load_dwordx4 v2, s[44:47], s12 offen nt lds
    s_mov_b32 m0, 38912
    s_add_u32 s12, s12, s13
    buffer_load_dwordx4 v3, s[44:47], s12 offen nt lds
    s_mov_b32 m0, 39936
    s_add_u32 s12, s12, s13
    buffer_load_dwordx4 v2, s[44:47], s12 offen nt lds
    s_mov_b32 m0, 40960
    s_add_u32 s12, s12, s13
    buffer_load_dwordx4 v3, s[44:47], s12 offen nt lds
    s_barrier
    s_waitcnt vmcnt(32)
    v_readfirstlane_b32 s8, v6
    s_nop 0
    s_mul_i32 s8, s8, 1664525
    s_add_u32 s68, s8, 1013904223
    v_lshlrev_b32 v24, 16, v8
    v_and_b32 v25, s69, v8
    v_lshlrev_b32 v26, 16, v9
    v_and_b32 v27, s69, v9
    v_lshlrev_b32 v28, 16, v10
    v_and_b32 v29, s69, v10
    v_lshlrev_b32 v30, 16, v11
    v_and_b32 v31, s69, v11
    v_lshlrev_b32 v32, 16, v12
    v_and_b32 v33, s69, v12
    v_lshlrev_b32 v34, 16, v13
    v_and_b32 v35, s69, v13
    v_lshlrev_b32 v36, 16, v14
    v_and_b32 v37, s69, v14
    v_lshlrev_b32 v38, 16, v15
    v_and_b32 v39, s69, v15
    v_lshlrev_b32 v40, 16, v16
    v_and_b32 v41, s69, v16
    v_lshlrev_b32 v42, 16, v17
    v_and_b32 v43, s69, v17
    v_lshlrev_b32 v44, 16, v18
    v_and_b32 v45, s69, v18
    v_lshlrev_b32 v46, 16, v19
    v_and_b32 v47, s69, v19
    v_lshlrev_b32 v48, 16, v20
    v_and_b32 v49, s69, v20
    v_lshlrev_b32 v50, 16, v21
    v_and_b32 v51, s69, v21
    v_lshlrev_b32 v52, 16, v22
    v_and_b32 v53, s69, v22
    v_lshlrev_b32 v54, 16, v23
    v_and_b32 v55, s69, v23
    v_pk_add_f32 v[56:57], v[24:25], v[26:27]
    v_pk_add_f32 v[58:59], v[28:29], v[30:31]
    v_pk_add_f32 v[60:61], v[32:33], v[34:35]
    v_pk_add_f32 v[62:63], v[36:37], v[38:39]
    v_pk_add_f32 v[64:65], v[40:41], v[42:43]
    v_pk_add_f32 v[66:67], v[44:45], v[46:47]
    v_pk_add_f32 v[68:69], v[48:49], v[50:51]
    v_pk_add_f32 v[70:71], v[52:53], v[54:55]
    v_pk_add_f32 v[56:57], v[56:57], v[58:59]
    v_pk_add_f32 v[60:61], v[60:61], v[62:63]
    v_pk_add_f32 v[64:65], v[64:65], v[66:67]
    v_pk_add_f32 v[68:69], v[68:69], v[70:71]
    v_add_f32 v8, v56, v57
    v_add_f32 v10, v60, v61
    v_add_f32 v12, v64, v65
    v_add_f32 v14, v68, v69
    v_add_f32_dpp v8, v8, v8 quad_perm:[1,0,3,2] row_mask:0xf bank_mask:0xf
    v_add_f32_dpp v10, v10, v10 quad_perm:[1,0,3,2] row_mask:0xf bank_mask:0xf
    v_add_f32_dpp v12, v12, v12 quad_perm:[1,0,3,2] row_mask:0xf bank_mask:0xf
    v_add_f32_dpp v14, v14, v14 quad_perm:[1,0,3,2] row_mask:0xf bank_mask:0xf
    v_add_f32_dpp v8, v8, v8 quad_perm:[2,3,0,1] row_mask:0xf bank_mask:0xf
    v_add_f32_dpp v10, v10, v10 quad_perm:[2,3,0,1] row_mask:0xf bank_mask:0xf
    v_add_f32_dpp v12, v12, v12 quad_perm:[2,3,0,1] row_mask:0xf bank_mask:0xf
    v_add_f32_dpp v14, v14, v14 quad_perm:[2,3,0,1] row_mask:0xf bank_mask:0xf
    v_add_f32_dpp v8, v8, v8 row_half_mirror row_mask:0xf bank_mask:0xf
    v_add_f32_dpp v10, v10, v10 row_half_mirror row_mask:0xf bank_mask:0xf
    v_add_f32_dpp v12, v12, v12 row_half_mirror row_mask:0xf bank_mask:0xf
    v_add_f32_dpp v14, v14, v14 row_half_mirror row_mask:0xf bank_mask:0xf
    v_add_f32_dpp v8, v8, v8 row_mirror row_mask:0xf bank_mask:0xf
    v_add_f32_dpp v10, v10, v10 row_mirror row_mask:0xf bank_mask:0xf
    v_add_f32_dpp v12, v12, v12 row_mirror row_mask:0xf bank_mask:0xf
    v_add_f32_dpp v14, v14, v14 row_mirror row_mask:0xf bank_mask:0xf
    v_mov_b32 v56, v8
    v_mov_b32 v57, v10
    v_mov_b32 v58, v12
    v_mov_b32 v59, v14
    v_permlane16_swap_b32 v56, v8
    v_permlane16_swap_b32 v57, v10
    v_permlane16_swap_b32 v58, v12
    v_permlane16_swap_b32 v59, v14
    v_add_f32 v8, v8, v56
    v_add_f32 v10, v10, v57
    v_add_f32 v12, v12, v58
    v_add_f32 v14, v14, v59
    v_mov_b32 v56, v8
    v_mov_b32 v57, v10
    v_mov_b32 v58, v12
    v_mov_b32 v59, v14
    v_permlane32_swap_b32 v56, v8
    v_permlane32_swap_b32 v57, v10
    v_permlane32_swap_b32 v58, v12
    v_permlane32_swap_b32 v59, v14
    v_add_f32 v8, v8, v56
    v_add_f32 v10, v10, v57
    v_add_f32 v12, v12, v58
    v_add_f32 v14, v14, v59
    s_mov_b32 s8, 0x3b000000
    v_mul_f32 v8, s8, v8
    v_mul_f32 v10, s8, v10
    v_mul_f32 v12, s8, v12
    v_mul_f32 v14, s8, v14
    v_pk_add_f32 v[56:57], v[24:25], v[8:9] op_sel_hi:[1,0] neg_lo:[0,1] neg_hi:[0,1]
    v_pk_add_f32 v[58:59], v[26:27], v[8:9] op_sel_hi:[1,0] neg_lo:[0,1] neg_hi:[0,1]
    v_pk_add_f32 v[60:61], v[28:29], v[8:9] op_sel_hi:[1,0] neg_lo:[0,1] neg_hi:[0,1]
    v_pk_add_f32 v[62:63], v[30:31], v[8:9] op_sel_hi:[1,0] neg_lo:[0,1] neg_hi:[0,1]
    v_pk_mul_f32 v[64:65], v[56:57], v[56:57]
    v_pk_fma_f32 v[64:65], v[58:59], v[58:59], v[64:65]
    v_pk_fma_f32 v[64:65], v[60:61], v[60:61], v[64:65]
    v_pk_fma_f32 v[64:65], v[62:63], v[62:63], v[64:65]
    v_add_f32 v16, v64, v65
    v_pk_add_f32 v[56:57], v[32:33], v[10:11] op_sel_hi:[1,0] neg_lo:[0,1] neg_hi:[0,1]
    v_pk_add_f32 v[58:59], v[34:35], v[10:11] op_sel_hi:[1,0] neg_lo:[0,1] neg_hi:[0,1]
    v_pk_add_f32 v[60:61], v[36:37], v[10:11] op_sel_hi:[1,0] neg_lo:[0,1] neg_hi:[0,1]
    v_pk_add_f32 v[62:63], v[38:39], v[10:11] op_sel_hi:[1,0] neg_lo:[0,1] neg_hi:[0,1]
    v_pk_mul_f32 v[64:65], v[56:57], v[56:57]
    v_pk_fma_f32 v[64:65], v[58:59], v[58:59], v[64:65]
    v_pk_fma_f32 v[64:65], v[60:61], v[60:61], v[64:65]
    v_pk_fma_f32 v[64:65], v[62:63], v[62:63], v[64:65]
    v_add_f32 v18, v64, v65
    v_pk_add_f32 v[56:57], v[40:41], v[12:13] op_sel_hi:[1,0] neg_lo:[0,1] neg_hi:[0,1]
    v_pk_add_f32 v[58:59], v[42:43], v[12:13] op_sel_hi:[1,0] neg_lo:[0,1] neg_hi:[0,1]
    v_pk_add_f32 v[60:61], v[44:45], v[12:13] op_sel_hi:[1,0] neg_lo:[0,1] neg_hi:[0,1]
    v_pk_add_f32 v[62:63], v[46:47], v[12:13] op_sel_hi:[1,0] neg_lo:[0,1] neg_hi:[0,1]
    v_pk_mul_f32 v[64:65], v[56:57], v[56:57]
    v_pk_fma_f32 v[64:65], v[58:59], v[58:59], v[64:65]
    v_pk_fma_f32 v[64:65], v[60:61], v[60:61], v[64:65]
    v_pk_fma_f32 v[64:65], v[62:63], v[62:63], v[64:65]
    v_add_f32 v20, v64, v65
    v_pk_add_f32 v[56:57], v[48:49], v[14:15] op_sel_hi:[1,0] neg_lo:[0,1] neg_hi:[0,1]
    v_pk_add_f32 v[58:59], v[50:51], v[14:15] op_sel_hi:[1,0] neg_lo:[0,1] neg_hi:[0,1]
    v_pk_add_f32 v[60:61], v[52:53], v[14:15] op_sel_hi:[1,0] neg_lo:[0,1] neg_hi:[0,1]
    v_pk_add_f32 v[62:63], v[54:55], v[14:15] op_sel_hi:[1,0] neg_lo:[0,1] neg_hi:[0,1]
    v_pk_mul_f32 v[64:65], v[56:57], v[56:57]
    v_pk_fma_f32 v[64:65], v[58:59], v[58:59], v[64:65]
    v_pk_fma_f32 v[64:65], v[60:61], v[60:61], v[64:65]
    v_pk_fma_f32 v[64:65], v[62:63], v[62:63], v[64:65]
    v_add_f32 v22, v64, v65
    v_add_f32_dpp v16, v16, v16 quad_perm:[1,0,3,2] row_mask:0xf bank_mask:0xf
    v_add_f32_dpp v18, v18, v18 quad_perm:[1,0,3,2] row_mask:0xf bank_mask:0xf
    v_add_f32_dpp v20, v20, v20 quad_perm:[1,0,3,2] row_mask:0xf bank_mask:0xf
    v_add_f32_dpp v22, v22, v22 quad_perm:[1,0,3,2] row_mask:0xf bank_mask:0xf
    v_add_f32_dpp v16, v16, v16 quad_perm:[2,3,0,1] row_mask:0xf bank_mask:0xf
    v_add_f32_dpp v18, v18, v18 quad_perm:[2,3,0,1] row_mask:0xf bank_mask:0xf
    v_add_f32_dpp v20, v20, v20 quad_perm:[2,3,0,1] row_mask:0xf bank_mask:0xf
    v_add_f32_dpp v22, v22, v22 quad_perm:[2,3,0,1] row_mask:0xf bank_mask:0xf
    v_add_f32_dpp v16, v16, v16 row_half_mirror row_mask:0xf bank_mask:0xf
    v_add_f32_dpp v18, v18, v18 row_half_mirror row_mask:0xf bank_mask:0xf
    v_add_f32_dpp v20, v20, v20 row_half_mirror row_mask:0xf bank_mask:0xf
    v_add_f32_dpp v22, v22, v22 row_half_mirror row_mask:0xf bank_mask:0xf
    v_add_f32_dpp v16, v16, v16 row_mirror row_mask:0xf bank_mask:0xf
    v_add_f32_dpp v18, v18, v18 row_mirror row_mask:0xf bank_mask:0xf
    v_add_f32_dpp v20, v20, v20 row_mirror row_mask:0xf bank_mask:0xf
    v_add_f32_dpp v22, v22, v22 row_mirror row_mask:0xf bank_mask:0xf
    v_mov_b32 v56, v16
    v_mov_b32 v57, v18
    v_mov_b32 v58, v20
    v_mov_b32 v59, v22
    v_permlane16_swap_b32 v56, v16
    v_permlane16_swap_b32 v57, v18
    v_permlane16_swap_b32 v58, v20
    v_permlane16_swap_b32 v59, v22
    v_add_f32 v16, v16, v56
    v_add_f32 v18, v18, v57
    v_add_f32 v20, v20, v58
    v_add_f32 v22, v22, v59
    v_mov_b32 v56, v16
    v_mov_b32 v57, v18
    v_mov_b32 v58, v20
    v_mov_b32 v59, v22
    v_permlane32_swap_b32 v56, v16
    v_permlane32_swap_b32 v57, v18
    v_permlane32_swap_b32 v58, v20
    v_permlane32_swap_b32 v59, v22
    v_add_f32 v16, v16, v56
    v_add_f32 v18, v18, v57
    v_add_f32 v20, v20, v58
    v_add_f32 v22, v22, v59
    v_mul_f32 v16, s8, v16
    v_mul_f32 v18, s8, v18
    v_mul_f32 v20, s8, v20
    v_mul_f32 v22, s8, v22
    v_cvt_pk_bf16_f32 v56, v8, v10
    v_lshlrev_b32 v8, 16, v56
    v_and_b32 v10, s69, v56
    v_cvt_pk_bf16_f32 v57, v12, v14
    v_lshlrev_b32 v12, 16, v57
    v_and_b32 v14, s69, v57
    v_cvt_pk_bf16_f32 v58, v16, v18
    v_lshlrev_b32 v16, 16, v58
    v_and_b32 v18, s69, v58
    v_cvt_pk_bf16_f32 v59, v20, v22
    v_lshlrev_b32 v20, 16, v59
    v_and_b32 v22, s69, v59
    s_mov_b32 s9, 0x3727c5ac
    v_add_f32 v16, s9, v16
    v_add_f32 v18, s9, v18
    v_add_f32 v20, s9, v20
    v_add_f32 v22, s9, v22
    v_cvt_pk_bf16_f32 v56, v16, v18
    v_lshlrev_b32 v16, 16, v56
    v_and_b32 v18, s69, v56
    v_cvt_pk_bf16_f32 v57, v20, v22
    v_lshlrev_b32 v20, 16, v57
    v_and_b32 v22, s69, v57
    v_sqrt_f32 v16, v16
    v_sqrt_f32 v18, v18
    v_sqrt_f32 v20, v20
    v_sqrt_f32 v22, v22
    v_cvt_pk_bf16_f32 v56, v16, v18
    v_lshlrev_b32 v16, 16, v56
    v_and_b32 v18, s69, v56
    v_cvt_pk_bf16_f32 v57, v20, v22
    v_lshlrev_b32 v20, 16, v57
    v_and_b32 v22, s69, v57
    v_rcp_f32 v16, v16
    v_rcp_f32 v18, v18
    v_rcp_f32 v20, v20
    v_rcp_f32 v22, v22
    v_pk_add_f32 v[24:25], v[24:25], v[8:9] op_sel_hi:[1,0] neg_lo:[0,1] neg_hi:[0,1]
    v_pk_add_f32 v[26:27], v[26:27], v[8:9] op_sel_hi:[1,0] neg_lo:[0,1] neg_hi:[0,1]
    v_pk_add_f32 v[28:29], v[28:29], v[8:9] op_sel_hi:[1,0] neg_lo:[0,1] neg_hi:[0,1]
    v_pk_add_f32 v[30:31], v[30:31], v[8:9] op_sel_hi:[1,0] neg_lo:[0,1] neg_hi:[0,1]
    v_cvt_pk_bf16_f32 v56, v24, v25
    v_lshlrev_b32 v24, 16, v56
    v_and_b32 v25, s69, v56
    v_cvt_pk_bf16_f32 v57, v26, v27
    v_lshlrev_b32 v26, 16, v57
    v_and_b32 v27, s69, v57
    v_cvt_pk_bf16_f32 v58, v28, v29
    v_lshlrev_b32 v28, 16, v58
    v_and_b32 v29, s69, v58
    v_cvt_pk_bf16_f32 v59, v30, v31
    v_lshlrev_b32 v30, 16, v59
    v_and_b32 v31, s69, v59
    v_pk_mul_f32 v[24:25], v[24:25], v[16:17] op_sel_hi:[1,0]
    v_pk_mul_f32 v[26:27], v[26:27], v[16:17] op_sel_hi:[1,0]
    v_pk_mul_f32 v[28:29], v[28:29], v[16:17] op_sel_hi:[1,0]
    v_pk_mul_f32 v[30:31], v[30:31], v[16:17] op_sel_hi:[1,0]
    v_cvt_pk_bf16_f32 v60, v24, v25
    v_cvt_pk_bf16_f32 v61, v26, v27
    v_cvt_pk_bf16_f32 v62, v28, v29
    v_cvt_pk_bf16_f32 v63, v30, v31
    v_pk_add_f32 v[32:33], v[32:33], v[10:11] op_sel_hi:[1,0] neg_lo:[0,1] neg_hi:[0,1]
    v_pk_add_f32 v[34:35], v[34:35], v[10:11] op_sel_hi:[1,0] neg_lo:[0,1] neg_hi:[0,1]
    v_pk_add_f32 v[36:37], v[36:37], v[10:11] op_sel_hi:[1,0] neg_lo:[0,1] neg_hi:[0,1]
    v_pk_add_f32 v[38:39], v[38:39], v[10:11] op_sel_hi:[1,0] neg_lo:[0,1] neg_hi:[0,1]
    v_cvt_pk_bf16_f32 v56, v32, v33
    v_lshlrev_b32 v32, 16, v56
    v_and_b32 v33, s69, v56
    v_cvt_pk_bf16_f32 v57, v34, v35
    v_lshlrev_b32 v34, 16, v57
    v_and_b32 v35, s69, v57
    v_cvt_pk_bf16_f32 v58, v36, v37
    v_lshlrev_b32 v36, 16, v58
    v_and_b32 v37, s69, v58
    v_cvt_pk_bf16_f32 v59, v38, v39
    v_lshlrev_b32 v38, 16, v59
    v_and_b32 v39, s69, v59
    v_pk_mul_f32 v[32:33], v[32:33], v[18:19] op_sel_hi:[1,0]
    v_pk_mul_f32 v[34:35], v[34:35], v[18:19] op_sel_hi:[1,0]
    v_pk_mul_f32 v[36:37], v[36:37], v[18:19] op_sel_hi:[1,0]
    v_pk_mul_f32 v[38:39], v[38:39], v[18:19] op_sel_hi:[1,0]
    v_cvt_pk_bf16_f32 v64, v32, v33
    v_cvt_pk_bf16_f32 v65, v34, v35
    v_cvt_pk_bf16_f32 v66, v36, v37
    v_cvt_pk_bf16_f32 v67, v38, v39
    v_pk_add_f32 v[40:41], v[40:41], v[12:13] op_sel_hi:[1,0] neg_lo:[0,1] neg_hi:[0,1]
    v_pk_add_f32 v[42:43], v[42:43], v[12:13] op_sel_hi:[1,0] neg_lo:[0,1] neg_hi:[0,1]
    v_pk_add_f32 v[44:45], v[44:45], v[12:13] op_sel_hi:[1,0] neg_lo:[0,1] neg_hi:[0,1]
    v_pk_add_f32 v[46:47], v[46:47], v[12:13] op_sel_hi:[1,0] neg_lo:[0,1] neg_hi:[0,1]
    v_cvt_pk_bf16_f32 v56, v40, v41
    v_lshlrev_b32 v40, 16, v56
    v_and_b32 v41, s69, v56
    v_cvt_pk_bf16_f32 v57, v42, v43
    v_lshlrev_b32 v42, 16, v57
    v_and_b32 v43, s69, v57
    v_cvt_pk_bf16_f32 v58, v44, v45
    v_lshlrev_b32 v44, 16, v58
    v_and_b32 v45, s69, v58
    v_cvt_pk_bf16_f32 v59, v46, v47
    v_lshlrev_b32 v46, 16, v59
    v_and_b32 v47, s69, v59
    v_pk_mul_f32 v[40:41], v[40:41], v[20:21] op_sel_hi:[1,0]
    v_pk_mul_f32 v[42:43], v[42:43], v[20:21] op_sel_hi:[1,0]
    v_pk_mul_f32 v[44:45], v[44:45], v[20:21] op_sel_hi:[1,0]
    v_pk_mul_f32 v[46:47], v[46:47], v[20:21] op_sel_hi:[1,0]
    v_cvt_pk_bf16_f32 v68, v40, v41
    v_cvt_pk_bf16_f32 v69, v42, v43
    v_cvt_pk_bf16_f32 v70, v44, v45
    v_cvt_pk_bf16_f32 v71, v46, v47
    v_pk_add_f32 v[48:49], v[48:49], v[14:15] op_sel_hi:[1,0] neg_lo:[0,1] neg_hi:[0,1]
    v_pk_add_f32 v[50:51], v[50:51], v[14:15] op_sel_hi:[1,0] neg_lo:[0,1] neg_hi:[0,1]
    v_pk_add_f32 v[52:53], v[52:53], v[14:15] op_sel_hi:[1,0] neg_lo:[0,1] neg_hi:[0,1]
    v_pk_add_f32 v[54:55], v[54:55], v[14:15] op_sel_hi:[1,0] neg_lo:[0,1] neg_hi:[0,1]
    v_cvt_pk_bf16_f32 v56, v48, v49
    v_lshlrev_b32 v48, 16, v56
    v_and_b32 v49, s69, v56
    v_cvt_pk_bf16_f32 v57, v50, v51
    v_lshlrev_b32 v50, 16, v57
    v_and_b32 v51, s69, v57
    v_cvt_pk_bf16_f32 v58, v52, v53
    v_lshlrev_b32 v52, 16, v58
    v_and_b32 v53, s69, v58
    v_cvt_pk_bf16_f32 v59, v54, v55
    v_lshlrev_b32 v54, 16, v59
    v_and_b32 v55, s69, v59
    v_pk_mul_f32 v[48:49], v[48:49], v[22:23] op_sel_hi:[1,0]
    v_pk_mul_f32 v[50:51], v[50:51], v[22:23] op_sel_hi:[1,0]
    v_pk_mul_f32 v[52:53], v[52:53], v[22:23] op_sel_hi:[1,0]
    v_pk_mul_f32 v[54:55], v[54:55], v[22:23] op_sel_hi:[1,0]
    v_cvt_pk_bf16_f32 v72, v48, v49
    v_cvt_pk_bf16_f32 v73, v50, v51
    v_cvt_pk_bf16_f32 v74, v52, v53
    v_cvt_pk_bf16_f32 v75, v54, v55
    v_add_u32 v5, 64, v1
    ds_write_b128 v5, v[60:63] offset:0
    ds_write_b128 v5, v[64:67] offset:1088
    ds_write_b128 v5, v[68:71] offset:2176
    ds_write_b128 v5, v[72:75] offset:3264
    v_and_b32 v6, 3, v0
    v_lshrrev_b32 v7, 4, v0
    v_mul_u32_u24 v5, 1088, v6
    v_lshl_add_u32 v5, v7, 4, v5
    s_and_b32 s8, s5, 1
    s_lshl_b32 s8, s8, 9
    s_add_u32 s8, s8, 64
    v_add_u32 v5, s8, v5
    s_waitcnt lgkmcnt(0)
    ds_read_b128 v[72:75], v5 offset:0
    ds_read_b128 v[76:79], v5 offset:64
    ds_read_b128 v[80:83], v5 offset:128
    ds_read_b128 v[84:87], v5 offset:192
    ds_read_b128 v[88:91], v5 offset:256
    ds_read_b128 v[92:95], v5 offset:320
    ds_read_b128 v[96:99], v5 offset:384
    ds_read_b128 v[100:103], v5 offset:448
    v_bfe_u32 v8, v0, 2, 2
    v_lshl_add_u32 v9, v7, 3, v8
    v_lshlrev_b32 v9, 7, v9
    v_lshl_add_u32 v9, v6, 3, v9
    v_add_u32 v9, 9216, v9
    v_lshrrev_b32 v10, 1, v8
    v_and_b32 v11, 1, v7
    v_lshl_add_u32 v10, v11, 1, v10
    v_xor_b32 v11, 0, v10
    v_lshl_add_u32 v24, v11, 5, v9
    v_xor_b32 v11, 1, v10
    v_lshl_add_u32 v25, v11, 5, v9
    v_xor_b32 v11, 2, v10
    v_lshl_add_u32 v26, v11, 5, v9
    v_xor_b32 v11, 3, v10
    v_lshl_add_u32 v27, v11, 5, v9
    s_waitcnt lgkmcnt(0)
    s_waitcnt vmcnt(28)
    ds_read_b64_tr_b16 v[136:137], v24 offset:0
    ds_read_b64_tr_b16 v[138:139], v24 offset:512
    ds_read_b64_tr_b16 v[140:141], v25 offset:0
    ds_read_b64_tr_b16 v[142:143], v25 offset:512
    ds_read_b64_tr_b16 v[144:145], v26 offset:0
    ds_read_b64_tr_b16 v[146:147], v26 offset:512
    ds_read_b64_tr_b16 v[148:149], v27 offset:0
    ds_read_b64_tr_b16 v[150:151], v27 offset:512
    s_waitcnt lgkmcnt(0)
    s_waitcnt vmcnt(24)
    ds_read_b64_tr_b16 v[152:153], v24 offset:4096
    ds_read_b64_tr_b16 v[154:155], v24 offset:4608
    ds_read_b64_tr_b16 v[156:157], v25 offset:4096
    ds_read_b64_tr_b16 v[158:159], v25 offset:4608
    ds_read_b64_tr_b16 v[160:161], v26 offset:4096
    ds_read_b64_tr_b16 v[162:163], v26 offset:4608
    ds_read_b64_tr_b16 v[164:165], v27 offset:4096
    ds_read_b64_tr_b16 v[166:167], v27 offset:4608
    v_mfma_f32_16x16x32_bf16 v[104:107], v[136:139], v[72:75], 0
    v_mfma_f32_16x16x32_bf16 v[108:111], v[140:143], v[72:75], 0
    v_mfma_f32_16x16x32_bf16 v[112:115], v[144:147], v[72:75], 0
    v_mfma_f32_16x16x32_bf16 v[116:119], v[148:151], v[72:75], 0
    s_waitcnt lgkmcnt(0)
    s_waitcnt vmcnt(20)
    ds_read_b64_tr_b16 v[136:137], v24 offset:8192
    ds_read_b64_tr_b16 v[138:139], v24 offset:8704
    ds_read_b64_tr_b16 v[140:141], v25 offset:8192
    ds_read_b64_tr_b16 v[142:143], v25 offset:8704
    ds_read_b64_tr_b16 v[144:145], v26 offset:8192
    ds_read_b64_tr_b16 v[146:147], v26 offset:8704
    ds_read_b64_tr_b16 v[148:149], v27 offset:8192
    ds_read_b64_tr_b16 v[150:151], v27 offset:8704
    v_mfma_f32_16x16x32_bf16 v[104:107], v[152:155], v[76:79], v[104:107]
    v_mfma_f32_16x16x32_bf16 v[108:111], v[156:159], v[76:79], v[108:111]
    v_mfma_f32_16x16x32_bf16 v[112:115], v[160:163], v[76:79], v[112:115]
    v_mfma_f32_16x16x32_bf16 v[116:119], v[164:167], v[76:79], v[116:119]
    s_waitcnt lgkmcnt(0)
    s_waitcnt vmcnt(16)
    ds_read_b64_tr_b16 v[152:153], v24 offset:12288
    ds_read_b64_tr_b16 v[154:155], v24 offset:12800
    ds_read_b64_tr_b16 v[156:157], v25 offset:12288
    ds_read_b64_tr_b16 v[158:159], v25 offset:12800
    ds_read_b64_tr_b16 v[160:161], v26 offset:12288
    ds_read_b64_tr_b16 v[162:163], v26 offset:12800
    ds_read_b64_tr_b16 v[164:165], v27 offset:12288
    ds_read_b64_tr_b16 v[166:167], v27 offset:12800
    v_mfma_f32_16x16x32_bf16 v[104:107], v[136:139], v[80:83], v[104:107]
    v_mfma_f32_16x16x32_bf16 v[108:111], v[140:143], v[80:83], v[108:111]
    v_mfma_f32_16x16x32_bf16 v[112:115], v[144:147], v[80:83], v[112:115]
    v_mfma_f32_16x16x32_bf16 v[116:119], v[148:151], v[80:83], v[116:119]
    s_waitcnt lgkmcnt(0)
    s_waitcnt vmcnt(12)
    ds_read_b64_tr_b16 v[136:137], v24 offset:16384
    ds_read_b64_tr_b16 v[138:139], v24 offset:16896
    ds_read_b64_tr_b16 v[140:141], v25 offset:16384
    ds_read_b64_tr_b16 v[142:143], v25 offset:16896
    ds_read_b64_tr_b16 v[144:145], v26 offset:16384
    ds_read_b64_tr_b16 v[146:147], v26 offset:16896
    ds_read_b64_tr_b16 v[148:149], v27 offset:16384
    ds_read_b64_tr_b16 v[150:151], v27 offset:16896
    v_mfma_f32_16x16x32_bf16 v[104:107], v[152:155], v[84:87], v[104:107]
    v_mfma_f32_16x16x32_bf16 v[108:111], v[156:159], v[84:87], v[108:111]
    v_mfma_f32_16x16x32_bf16 v[112:115], v[160:163], v[84:87], v[112:115]
    v_mfma_f32_16x16x32_bf16 v[116:119], v[164:167], v[84:87], v[116:119]
    s_waitcnt lgkmcnt(0)
    s_waitcnt vmcnt(8)
    ds_read_b64_tr_b16 v[152:153], v24 offset:20480
    ds_read_b64_tr_b16 v[154:155], v24 offset:20992
    ds_read_b64_tr_b16 v[156:157], v25 offset:20480
    ds_read_b64_tr_b16 v[158:159], v25 offset:20992
    ds_read_b64_tr_b16 v[160:161], v26 offset:20480
    ds_read_b64_tr_b16 v[162:163], v26 offset:20992
    ds_read_b64_tr_b16 v[164:165], v27 offset:20480
    ds_read_b64_tr_b16 v[166:167], v27 offset:20992
    v_mfma_f32_16x16x32_bf16 v[104:107], v[136:139], v[88:91], v[104:107]
    v_mfma_f32_16x16x32_bf16 v[108:111], v[140:143], v[88:91], v[108:111]
    v_mfma_f32_16x16x32_bf16 v[112:115], v[144:147], v[88:91], v[112:115]
    v_mfma_f32_16x16x32_bf16 v[116:119], v[148:151], v[88:91], v[116:119]
    s_waitcnt lgkmcnt(0)
    s_waitcnt vmcnt(4)
    ds_read_b64_tr_b16 v[136:137], v24 offset:24576
    ds_read_b64_tr_b16 v[138:139], v24 offset:25088
    ds_read_b64_tr_b16 v[140:141], v25 offset:24576
    ds_read_b64_tr_b16 v[142:143], v25 offset:25088
    ds_read_b64_tr_b16 v[144:145], v26 offset:24576
    ds_read_b64_tr_b16 v[146:147], v26 offset:25088
    ds_read_b64_tr_b16 v[148:149], v27 offset:24576
    ds_read_b64_tr_b16 v[150:151], v27 offset:25088
    v_mfma_f32_16x16x32_bf16 v[104:107], v[152:155], v[92:95], v[104:107]
    v_mfma_f32_16x16x32_bf16 v[108:111], v[156:159], v[92:95], v[108:111]
    v_mfma_f32_16x16x32_bf16 v[112:115], v[160:163], v[92:95], v[112:115]
    v_mfma_f32_16x16x32_bf16 v[116:119], v[164:167], v[92:95], v[116:119]
    s_waitcnt lgkmcnt(0)
    s_waitcnt vmcnt(0)
    ds_read_b64_tr_b16 v[152:153], v24 offset:28672
    ds_read_b64_tr_b16 v[154:155], v24 offset:29184
    ds_read_b64_tr_b16 v[156:157], v25 offset:28672
    ds_read_b64_tr_b16 v[158:159], v25 offset:29184
    ds_read_b64_tr_b16 v[160:161], v26 offset:28672
    ds_read_b64_tr_b16 v[162:163], v26 offset:29184
    ds_read_b64_tr_b16 v[164:165], v27 offset:28672
    ds_read_b64_tr_b16 v[166:167], v27 offset:29184
    v_mfma_f32_16x16x32_bf16 v[104:107], v[136:139], v[96:99], v[104:107]
    v_mfma_f32_16x16x32_bf16 v[108:111], v[140:143], v[96:99], v[108:111]
    v_mfma_f32_16x16x32_bf16 v[112:115], v[144:147], v[96:99], v[112:115]
    v_mfma_f32_16x16x32_bf16 v[116:119], v[148:151], v[96:99], v[116:119]
    s_waitcnt lgkmcnt(0)
    v_mfma_f32_16x16x32_bf16 v[104:107], v[152:155], v[100:103], v[104:107]
    v_mfma_f32_16x16x32_bf16 v[108:111], v[156:159], v[100:103], v[108:111]
    v_mfma_f32_16x16x32_bf16 v[112:115], v[160:163], v[100:103], v[112:115]
    v_mfma_f32_16x16x32_bf16 v[116:119], v[164:167], v[100:103], v[116:119]
    v_and_b32 v8, 15, v0
    v_mul_u32_u24 v8, 272, v8
    v_lshl_add_u32 v8, v7, 4, v8
    v_add_u32 v8, 5760, v8
    v_lshrrev_b32 v9, 5, v0
    v_mul_u32_u24 v10, 272, v9
    v_and_b32 v11, 31, v0
    v_lshl_add_u32 v10, v11, 3, v10
    v_add_u32 v10, 5760, v10
    s_lshl_b32 s10, s14, 1
    s_and_b32 s11, s5, 1
    s_add_u32 s10, s10, s11
    s_lshl_b32 s8, s4, 6
    s_add_u32 s8, s8, s10
    s_lshl_b32 s8, s8, 10
    s_add_u32 s70, s8, 6291968
    s_add_u32 s71, s70, 0x8000
    v_lshlrev_b32 v14, 14, v9
    v_lshl_add_u32 v14, v11, 4, v14
    v_lshlrev_b32 v13, 10, v9
    v_lshl_add_u32 v13, v11, 4, v13
    s_mov_b32 exec_lo, 0xf000f
    s_mov_b32 exec_hi, 0xf000f
    ds_write_b128 v8, v[104:107] offset:0
    ds_write_b128 v8, v[108:111] offset:64
    ds_write_b128 v8, v[112:115] offset:128
    ds_write_b128 v8, v[116:119] offset:192
    s_mov_b64 exec, -1
    s_waitcnt lgkmcnt(0)
    ds_read_b64 v[16:17], v10
    ds_read_b64 v[20:21], v10 offset:544
    v_mov_b32 v19, s68
    v_mov_b32 v23, s68
    s_waitcnt lgkmcnt(0)
    v_mov_b32 v18, v17
    v_mov_b32 v22, v21
    v_mov_b32 v17, s68
    v_mov_b32 v21, s68
    s_mov_b32 s63, 0
    s_cmp_lt_u32 s5, 16
    s_cbranch_scc0 L_pubglob
    s_add_u32 s8, s70, 524288
    s_add_u32 s9, s71, 524288
    buffer_store_dwordx4 v[16:19], v14, s[64:67], s8 offen
    buffer_store_dwordx4 v[20:23], v14, s[64:67], s9 offen
    s_mov_b32 s63, 1
    s_branch L_pubdone
L_pubglob:
    s_and_b32 s8, s5, 1
    s_cmp_eq_u32 s8, 1
    s_cbranch_scc1 L_pub_h1
    v_mov_b32 v96, v16
    v_mov_b32 v97, v18
    v_mov_b32 v16, v20
    v_mov_b32 v17, v21
    v_mov_b32 v18, v22
    v_mov_b32 v19, v23
    s_branch L_pub_send
L_pub_h1:
    v_mov_b32 v96, v20
    v_mov_b32 v97, v22
L_pub_send:
    s_lshl_b32 s8, s2, 11
    s_add_u32 s9, s8, 7864832
    s_add_u32 s70, s8, 7340544
    buffer_store_dwordx4 v[16:19], v13, s[64:67], s9 offen
    s_xor_b32 s8, s2, 8
    s_lshl_b32 s8, s8, 11
    s_add_u32 s12, s8, 7340544
    s_add_u32 s13, s8, 7864832
    s_mov_b32 s75, 0
L_px:
    s_and_b32 s9, s75, 1
    s_cmp_ge_u32 s75, 12
    s_cselect_b32 s9, s9, 0
    s_cmp_eq_u32 s9, 1
    s_cselect_b32 s8, s12, s13
    buffer_load_dwordx4 v[24:27], v13, s[64:67], s8 offen sc1
    s_add_u32 s75, s75, 1
    s_waitcnt vmcnt(0)
    v_xor_b32 v28, s68, v25
    v_bitop3_b32 v28, v27, s68, v28 bitop3:0xbe
    v_cmp_ne_u32 vcc, 0, v28
    s_cmp_gt_u32 s75, 262144
    s_cbranch_scc1 L_pxdone
    s_cbranch_vccz L_pxdone
    s_cmp_lg_u32 s75, 2
    s_cbranch_scc1 L_px_nog
    buffer_store_dwordx4 v[16:19], v13, s[64:67], s70 offen sc1
L_px_nog:
    s_sleep 2
    s_branch L_px
L_pxdone:
    s_cmp_gt_u32 s75, 2
    s_cbranch_scc1 L_px_pub
    buffer_store_dwordx4 v[16:19], v13, s[64:67], s70 offen sc1
L_px_pub:
    v_add_f32 v96, v96, v24
    v_add_f32 v97, v97, v26
    s_cmp_eq_u32 s15, 1
    s_cbranch_scc1 L_noact
    v_cvt_pk_bf16_f32 v28, v96, v97
    v_lshlrev_b32 v96, 16, v28
    v_and_b32 v97, s69, v28
    s_mov_b32 s70, 0x3fb8aa3b
    v_mul_f32 v28, s70, v96
    v_mul_f32 v29, s70, v97
    v_exp_f32 v28, -v28
    v_exp_f32 v29, -v29
    v_add_f32 v28, 1.0, v28
    v_add_f32 v29, 1.0, v29
    v_rcp_f32 v28, v28
    v_rcp_f32 v29, v29
    v_mul_f32 v96, v96, v28
    v_mul_f32 v97, v97, v29
L_noact:
    v_cvt_pk_bf16_f32 v28, v96, v97
    v_mov_b32 v29, s68
    s_and_b32 s8, s5, 1
    s_lshl_b32 s8, s8, 1
    s_lshl_b32 s9, s15, 2
    s_add_u32 s8, s8, s9
    s_mul_i32 s8, s8, 14336
    s_lshr_b32 s9, s14, 1
    s_lshl_b32 s9, s9, 10
    s_add_u32 s8, s8, s9
    s_and_b32 s9, s14, 1
    s_lshl_b32 s9, s9, 8
    s_add_u32 s8, s8, s9
    s_add_u32 s8, s8, 262656
    v_lshrrev_b32 v30, 5, v0
    v_mul_u32_u24 v30, 14336, v30
    v_and_b32 v31, 31, v0
    v_lshl_add_u32 v30, v31, 3, v30
    buffer_store_dwordx2 v[28:29], v30, s[64:67], s8 offen sc1
L_pubdone:
    s_branch L_gather
L_noearly:
    s_barrier
    s_mov_b32 s63, 0
    s_mov_b32 s70, 0
    s_mov_b32 s71, 0
    v_mov_b32 v14, 0
    s_waitcnt vmcnt(0)
    v_readfirstlane_b32 s8, v6
    s_nop 0
    s_mul_i32 s8, s8, 1664525
    s_add_u32 s68, s8, 1013904223
L_gather:
    s_lshl_b32 s8, s4, 2
    s_add_u32 s8, s8, s6
    s_lshl_b32 s8, s8, 14
    s_add_u32 s12, s8, 6291968
    s_add_u32 s13, s8, 6816256
    v_lshrrev_b32 v13, 5, v0
    v_lshlrev_b32 v13, 10, v13
    v_and_b32 v12, 31, v0
    v_lshl_add_u32 v13, v12, 4, v13
    s_mov_b32 s75, 0
L_gq:
    s_and_b32 s9, s75, 1
    s_cmp_ge_u32 s75, 12
    s_cselect_b32 s9, s9, 0
    s_cmp_eq_u32 s9, 1
    s_cselect_b32 s8, s12, s13
    buffer_load_dwordx4 v[24:27], v13, s[64:67], s8 offen offset:0 sc1
    buffer_load_dwordx4 v[28:31], v13, s[64:67], s8 offen offset:2048 sc1
    s_add_u32 s8, s8, 4096
    buffer_load_dwordx4 v[32:35], v13, s[64:67], s8 offen offset:0 sc1
    buffer_load_dwordx4 v[36:39], v13, s[64:67], s8 offen offset:2048 sc1
    s_add_u32 s8, s8, 4096
    buffer_load_dwordx4 v[40:43], v13, s[64:67], s8 offen offset:0 sc1
    buffer_load_dwordx4 v[44:47], v13, s[64:67], s8 offen offset:2048 sc1
    s_add_u32 s8, s8, 4096
    buffer_load_dwordx4 v[48:51], v13, s[64:67], s8 offen offset:0 sc1
    buffer_load_dwordx4 v[52:55], v13, s[64:67], s8 offen offset:2048 sc1
    s_add_u32 s75, s75, 1
    s_waitcnt vmcnt(0)
    v_xor_b32 v60, s68, v25
    v_bitop3_b32 v60, v27, s68, v60 bitop3:0xbe
    v_bitop3_b32 v60, v29, s68, v60 bitop3:0xbe
    v_bitop3_b32 v60, v31, s68, v60 bitop3:0xbe
    v_bitop3_b32 v60, v33, s68, v60 bitop3:0xbe
    v_bitop3_b32 v60, v35, s68, v60 bitop3:0xbe
    v_bitop3_b32 v60, v37, s68, v60 bitop3:0xbe
    v_bitop3_b32 v60, v39, s68, v60 bitop3:0xbe
    v_xor_b32 v61, s68, v41
    v_bitop3_b32 v61, v43, s68, v61 bitop3:0xbe
    v_bitop3_b32 v61, v45, s68, v61 bitop3:0xbe
    v_bitop3_b32 v61, v47, s68, v61 bitop3:0xbe
    v_bitop3_b32 v61, v49, s68, v61 bitop3:0xbe
    v_bitop3_b32 v61, v51, s68, v61 bitop3:0xbe
    v_bitop3_b32 v61, v53, s68, v61 bitop3:0xbe
    v_bitop3_b32 v61, v55, s68, v61 bitop3:0xbe
    v_or_b32 v60, v60, v61
    v_cmp_ne_u32 vcc, 0, v60
    s_cmp_gt_u32 s75, 262144
    s_cbranch_scc1 L_gqdone
    s_cbranch_vccz L_gqdone
    s_cmp_lt_u32 s75, 2
    s_cbranch_scc1 L_gq_nog
    s_cmp_eq_u32 s63, 0
    s_cbranch_scc1 L_gq_nog
    buffer_store_dwordx4 v[16:19], v14, s[64:67], s70 offen sc1
    buffer_store_dwordx4 v[20:23], v14, s[64:67], s71 offen sc1
    s_mov_b32 s63, 0
L_gq_nog:
    s_sleep 2
    s_branch L_gq
L_gqdone:
    v_permlane32_swap_b32 v24, v28
    v_permlane32_swap_b32 v26, v30
    v_permlane32_swap_b32 v32, v36
    v_permlane32_swap_b32 v34, v38
    v_permlane32_swap_b32 v40, v44
    v_permlane32_swap_b32 v42, v46
    v_permlane32_swap_b32 v48, v52
    v_permlane32_swap_b32 v50, v54
    v_add_f32 v24, v24, v28
    v_add_f32 v26, v26, v30
    v_add_f32 v32, v32, v36
    v_add_f32 v34, v34, v38
    v_add_f32 v40, v40, v44
    v_add_f32 v42, v42, v46
    v_add_f32 v48, v48, v52
    v_add_f32 v50, v50, v54
    v_cvt_pk_bf16_f32 v24, v24, v26
    v_cvt_pk_bf16_f32 v32, v32, v34
    v_cvt_pk_bf16_f32 v40, v40, v42
    v_cvt_pk_bf16_f32 v48, v48, v50
    v_lshlrev_b32 v60, 2, v0
    v_add_u32 v60, 4480, v60
    ds_write_b32 v60, v24 offset:0
    ds_write_b32 v60, v32 offset:320
    ds_write_b32 v60, v40 offset:640
    ds_write_b32 v60, v48 offset:960
    s_cmp_eq_u32 s63, 0
    s_cbranch_scc1 L_gq_pub
    buffer_store_dwordx4 v[16:19], v14, s[64:67], s70 offen sc1
    buffer_store_dwordx4 v[20:23], v14, s[64:67], s71 offen sc1
    s_mov_b32 s63, 0
L_gq_pub:
    v_mov_b32 v61, 0
    v_mov_b32 v62, 1
    v_mov_b32 v63, s68
    s_waitcnt lgkmcnt(0)
    ds_write_b64 v61, v[62:63]
    s_cmp_eq_u32 s62, 1
    s_cbranch_scc1 L_wrole
    s_cmp_lt_u32 s5, 16
    s_cbranch_scc1 L_svc_end
    s_cmp_ge_u32 s5, 23
    s_cbranch_scc1 L_svc_end
    s_branch L_drole
L_wrole:
    s_mov_b32 s48, s24
    s_and_b32 s49, s25, 0xffff
    s_mov_b32 s50, 0x400000
    s_mov_b32 s51, 0x20000
    v_lshrrev_b32 v14, 5, v0
    v_lshlrev_b32 v14, 10, v14
    v_and_b32 v15, 31, v0
    v_lshl_add_u32 v14, v15, 4, v14
    s_lshl_b32 s12, s4, 9
    s_lshr_b32 s9, s60, 1
    s_lshl_b32 s9, s9, 6
    s_add_u32 s12, s12, s9
    s_lshl_b32 s12, s12, 10
    s_and_b32 s9, s60, 1
    s_lshl_b32 s9, s9, 9
    s_add_u32 s12, s12, s9
    s_barrier
    s_mov_b32 m0, 41984
    s_nop 0
    buffer_load_dwordx4 v14, s[48:51], s12 offen nt lds
    s_mov_b32 m0, 43008
    s_add_u32 s12, s12, 2048
    buffer_load_dwordx4 v14, s[48:51], s12 offen nt lds
    s_mov_b32 m0, 44032
    s_add_u32 s12, s12, 2048
    buffer_load_dwordx4 v14, s[48:51], s12 offen nt lds
    s_mov_b32 m0, 45056
    s_add_u32 s12, s12, 2048
    buffer_load_dwordx4 v14, s[48:51], s12 offen nt lds
    s_mov_b32 m0, 46080
    s_add_u32 s12, s12, 2048
    buffer_load_dwordx4 v14, s[48:51], s12 offen nt lds
    s_mov_b32 m0, 47104
    s_add_u32 s12, s12, 2048
    buffer_load_dwordx4 v14, s[48:51], s12 offen nt lds
    s_mov_b32 m0, 48128
    s_add_u32 s12, s12, 2048
    buffer_load_dwordx4 v14, s[48:51], s12 offen nt lds
    s_mov_b32 m0, 49152
    s_add_u32 s12, s12, 2048
    buffer_load_dwordx4 v14, s[48:51], s12 offen nt lds
    s_mov_b32 m0, 50176
    s_add_u32 s12, s12, 2048
    buffer_load_dwordx4 v14, s[48:51], s12 offen nt lds
    s_mov_b32 m0, 51200
    s_add_u32 s12, s12, 2048
    buffer_load_dwordx4 v14, s[48:51], s12 offen nt lds
    s_mov_b32 m0, 52224
    s_add_u32 s12, s12, 2048
    buffer_load_dwordx4 v14, s[48:51], s12 offen nt lds
    s_mov_b32 m0, 53248
    s_add_u32 s12, s12, 2048
    buffer_load_dwordx4 v14, s[48:51], s12 offen nt lds
    s_mov_b32 m0, 54272
    s_add_u32 s12, s12, 2048
    buffer_load_dwordx4 v14, s[48:51], s12 offen nt lds
    s_mov_b32 m0, 55296
    s_add_u32 s12, s12, 2048
    buffer_load_dwordx4 v14, s[48:51], s12 offen nt lds
    s_mov_b32 m0, 56320
    s_add_u32 s12, s12, 2048
    buffer_load_dwordx4 v14, s[48:51], s12 offen nt lds
    s_mov_b32 m0, 57344
    s_add_u32 s12, s12, 2048
    buffer_load_dwordx4 v14, s[48:51], s12 offen nt lds
    s_mov_b32 m0, 58368
    s_add_u32 s12, s12, 2048
    buffer_load_dwordx4 v14, s[48:51], s12 offen nt lds
    s_mov_b32 m0, 59392
    s_add_u32 s12, s12, 2048
    buffer_load_dwordx4 v14, s[48:51], s12 offen nt lds
    s_mov_b32 m0, 60416
    s_add_u32 s12, s12, 2048
    buffer_load_dwordx4 v14, s[48:51], s12 offen nt lds
    s_mov_b32 m0, 61440
    s_add_u32 s12, s12, 2048
    buffer_load_dwordx4 v14, s[48:51], s12 offen nt lds
    s_mov_b32 m0, 62464
    s_add_u32 s12, s12, 2048
    buffer_load_dwordx4 v14, s[48:51], s12 offen nt lds
    s_mov_b32 m0, 63488
    s_add_u32 s12, s12, 2048
    buffer_load_dwordx4 v14, s[48:51], s12 offen nt lds
    s_mov_b32 m0, 64512
    s_add_u32 s12, s12, 2048
    buffer_load_dwordx4 v14, s[48:51], s12 offen nt lds
    s_mov_b32 m0, 65536
    s_add_u32 s12, s12, 2048
    buffer_load_dwordx4 v14, s[48:51], s12 offen nt lds
    s_mov_b32 m0, 66560
    s_add_u32 s12, s12, 2048
    buffer_load_dwordx4 v14, s[48:51], s12 offen nt lds
    s_mov_b32 m0, 67584
    s_add_u32 s12, s12, 2048
    buffer_load_dwordx4 v14, s[48:51], s12 offen nt lds
    s_mov_b32 m0, 68608
    s_add_u32 s12, s12, 2048
    buffer_load_dwordx4 v14, s[48:51], s12 offen nt lds
    s_mov_b32 m0, 69632
    s_add_u32 s12, s12, 2048
    buffer_load_dwordx4 v14, s[48:51], s12 offen nt lds
    s_mov_b32 m0, 70656
    s_add_u32 s12, s12, 2048
    buffer_load_dwordx4 v14, s[48:51], s12 offen nt lds
    s_mov_b32 m0, 71680
    s_add_u32 s12, s12, 2048
    buffer_load_dwordx4 v14, s[48:51], s12 offen nt lds
    s_mov_b32 m0, 72704
    s_add_u32 s12, s12, 2048
    buffer_load_dwordx4 v14, s[48:51], s12 offen nt lds
    s_mov_b32 m0, 73728
    s_add_u32 s12, s12, 2048
    buffer_load_dwordx4 v14, s[48:51], s12 offen nt lds
    s_barrier
    s_waitcnt vmcnt(0)
    v_mov_b32 v16, 12
    v_mov_b32 v17, 1
    ds_write_b32 v16, v17
    s_branch L_svc_end
L_drole:
    s_sub_u32 s14, s5, 16
    s_lshl_b32 s8, s14, 11
    s_add_u32 s8, s8, 262656
    s_add_u32 s9, s8, 14336
    s_add_u32 s10, s8, 28672
    s_add_u32 s11, s8, 43008
    s_add_u32 s12, s8, 57344
    s_add_u32 s13, s8, 71680
    s_add_u32 s15, s8, 86016
    s_add_u32 s70, s8, 100352
    s_mov_b32 s75, 0
L_gh:
    buffer_load_dwordx4 v[24:27], v13, s[64:67], s8 offen sc1
    buffer_load_dwordx4 v[28:31], v13, s[64:67], s9 offen sc1
    buffer_load_dwordx4 v[32:35], v13, s[64:67], s10 offen sc1
    buffer_load_dwordx4 v[36:39], v13, s[64:67], s11 offen sc1
    buffer_load_dwordx4 v[40:43], v13, s[64:67], s12 offen sc1
    buffer_load_dwordx4 v[44:47], v13, s[64:67], s13 offen sc1
    buffer_load_dwordx4 v[48:51], v13, s[64:67], s15 offen sc1
    buffer_load_dwordx4 v[52:55], v13, s[64:67], s70 offen sc1
    s_add_u32 s75, s75, 1
    s_waitcnt vmcnt(0)
    v_xor_b32 v16, s68, v25
    v_bitop3_b32 v16, v27, s68, v16 bitop3:0xbe
    v_bitop3_b32 v16, v29, s68, v16 bitop3:0xbe
    v_bitop3_b32 v16, v31, s68, v16 bitop3:0xbe
    v_bitop3_b32 v16, v33, s68, v16 bitop3:0xbe
    v_bitop3_b32 v16, v35, s68, v16 bitop3:0xbe
    v_bitop3_b32 v16, v37, s68, v16 bitop3:0xbe
    v_bitop3_b32 v16, v39, s68, v16 bitop3:0xbe
    v_xor_b32 v17, s68, v41
    v_bitop3_b32 v17, v43, s68, v17 bitop3:0xbe
    v_bitop3_b32 v17, v45, s68, v17 bitop3:0xbe
    v_bitop3_b32 v17, v47, s68, v17 bitop3:0xbe
    v_bitop3_b32 v17, v49, s68, v17 bitop3:0xbe
    v_bitop3_b32 v17, v51, s68, v17 bitop3:0xbe
    v_bitop3_b32 v17, v53, s68, v17 bitop3:0xbe
    v_bitop3_b32 v17, v55, s68, v17 bitop3:0xbe
    v_or_b32 v16, v16, v17
    v_cmp_ne_u32 vcc, 0, v16
    s_cmp_gt_u32 s75, 262144
    s_cbranch_scc1 L_ghdone
    s_cbranch_vccz L_ghdone
    s_sleep 2
    s_branch L_gh
L_ghdone:
    v_lshlrev_b32 v60, 16, v24
    v_and_b32 v61, s69, v24
    v_lshlrev_b32 v62, 16, v40
    v_and_b32 v63, s69, v40
    v_pk_mul_f32 v[60:61], v[60:61], v[62:63]
    v_cvt_pk_bf16_f32 v64, v60, v61
    v_lshlrev_b32 v60, 16, v26
    v_and_b32 v61, s69, v26
    v_lshlrev_b32 v62, 16, v42
    v_and_b32 v63, s69, v42
    v_pk_mul_f32 v[60:61], v[60:61], v[62:63]
    v_cvt_pk_bf16_f32 v65, v60, v61
    v_lshlrev_b32 v60, 16, v28
    v_and_b32 v61, s69, v28
    v_lshlrev_b32 v62, 16, v44
    v_and_b32 v63, s69, v44
    v_pk_mul_f32 v[60:61], v[60:61], v[62:63]
    v_cvt_pk_bf16_f32 v66, v60, v61
    v_lshlrev_b32 v60, 16, v30
    v_and_b32 v61, s69, v30
    v_lshlrev_b32 v62, 16, v46
    v_and_b32 v63, s69, v46
    v_pk_mul_f32 v[60:61], v[60:61], v[62:63]
    v_cvt_pk_bf16_f32 v67, v60, v61
    v_lshlrev_b32 v60, 16, v32
    v_and_b32 v61, s69, v32
    v_lshlrev_b32 v62, 16, v48
    v_and_b32 v63, s69, v48
    v_pk_mul_f32 v[60:61], v[60:61], v[62:63]
    v_cvt_pk_bf16_f32 v68, v60, v61
    v_lshlrev_b32 v60, 16, v34
    v_and_b32 v61, s69, v34
    v_lshlrev_b32 v62, 16, v50
    v_and_b32 v63, s69, v50
    v_pk_mul_f32 v[60:61], v[60:61], v[62:63]
    v_cvt_pk_bf16_f32 v69, v60, v61
    v_lshlrev_b32 v60, 16, v36
    v_and_b32 v61, s69, v36
    v_lshlrev_b32 v62, 16, v52
    v_and_b32 v63, s69, v52
    v_pk_mul_f32 v[60:61], v[60:61], v[62:63]
    v_cvt_pk_bf16_f32 v70, v60, v61
    v_lshlrev_b32 v60, 16, v38
    v_and_b32 v61, s69, v38
    v_lshlrev_b32 v62, 16, v54
    v_and_b32 v63, s69, v54
    v_pk_mul_f32 v[60:61], v[60:61], v[62:63]
    v_cvt_pk_bf16_f32 v71, v60, v61
    v_lshlrev_b32 v16, 3, v0
    v_add_u32 v16, 5760, v16
    ds_write_b64 v16, v[64:65] offset:0
    ds_write_b64 v16, v[66:67] offset:576
    ds_write_b64 v16, v[68:69] offset:1152
    ds_write_b64 v16, v[70:71] offset:1728
    v_and_b32 v6, 3, v0
    v_lshrrev_b32 v7, 4, v0
    v_mul_u32_u24 v5, 576, v6
    v_lshl_add_u32 v5, v7, 4, v5
    v_add_u32 v5, 5760, v5
    s_waitcnt lgkmcnt(0)
    ds_read_b128 v[72:75], v5 offset:0
    ds_read_b128 v[76:79], v5 offset:64
    ds_read_b128 v[80:83], v5 offset:128
    ds_read_b128 v[84:87], v5 offset:192
    ds_read_b128 v[88:91], v5 offset:256
    ds_read_b128 v[92:95], v5 offset:320
    ds_read_b128 v[96:99], v5 offset:384
    ds_read_b128 v[100:103], v5 offset:448
    s_mov_b32 s48, s32
    s_and_b32 s49, s33, 0xffff
    s_mov_b32 s50, 0x1c0000
    s_mov_b32 s51, 0x20000
    v_lshrrev_b32 v14, 3, v0
    v_lshlrev_b32 v14, 10, v14
    v_and_b32 v15, 7, v0
    v_lshl_add_u32 v14, v15, 4, v14
    s_lshl_b32 s12, s14, 18
    s_lshl_b32 s9, s4, 7
    s_add_u32 s12, s12, s9
    v_bfe_u32 v8, v0, 2, 2
    v_lshl_add_u32 v8, v7, 3, v8
    v_lshlrev_b32 v9, 7, v8
    v_lshl_add_u32 v9, v6, 3, v9
    v_add_u32 v10, 41984, v9
    v_lshrrev_b32 v11, 5, v0
    v_bfe_u32 v12, v0, 2, 2
    v_lshl_add_u32 v11, v11, 2, v12
    v_lshlrev_b32 v11, 11, v11
    v_lshl_add_u32 v11, v6, 4, v11
    v_bfe_u32 v12, v0, 4, 1
    v_lshl_add_u32 v11, v12, 6, v11
    s_lshl_b32 s13, s4, 15
    s_lshr_b32 s9, s14, 2
    s_lshl_b32 s9, s9, 10
    s_add_u32 s13, s13, s9
    s_and_b32 s9, s14, 3
    s_lshl_b32 s9, s9, 7
    s_add_u32 s13, s13, s9
    s_add_u32 s13, s13, 524800
    s_waitcnt lgkmcnt(0)
    s_barrier
    s_mov_b32 m0, 41984
    s_nop 0
    buffer_load_dwordx4 v14, s[48:51], s12 offen nt lds
    s_mov_b32 m0, 43008
    s_add_u32 s12, s12, 8192
    buffer_load_dwordx4 v14, s[48:51], s12 offen nt lds
    s_mov_b32 m0, 44032
    s_add_u32 s12, s12, 8192
    buffer_load_dwordx4 v14, s[48:51], s12 offen nt lds
    s_mov_b32 m0, 45056
    s_add_u32 s12, s12, 8192
    buffer_load_dwordx4 v14, s[48:51], s12 offen nt lds
    s_mov_b32 m0, 46080
    s_add_u32 s12, s12, 8192
    buffer_load_dwordx4 v14, s[48:51], s12 offen nt lds
    s_mov_b32 m0, 47104
    s_add_u32 s12, s12, 8192
    buffer_load_dwordx4 v14, s[48:51], s12 offen nt lds
    s_mov_b32 m0, 48128
    s_add_u32 s12, s12, 8192
    buffer_load_dwordx4 v14, s[48:51], s12 offen nt lds
    s_mov_b32 m0, 49152
    s_add_u32 s12, s12, 8192
    buffer_load_dwordx4 v14, s[48:51], s12 offen nt lds
    s_mov_b32 m0, 50176
    s_add_u32 s12, s12, 8192
    buffer_load_dwordx4 v14, s[48:51], s12 offen nt lds
    s_mov_b32 m0, 51200
    s_add_u32 s12, s12, 8192
    buffer_load_dwordx4 v14, s[48:51], s12 offen nt lds
    s_mov_b32 m0, 52224
    s_add_u32 s12, s12, 8192
    buffer_load_dwordx4 v14, s[48:51], s12 offen nt lds
    s_mov_b32 m0, 53248
    s_add_u32 s12, s12, 8192
    buffer_load_dwordx4 v14, s[48:51], s12 offen nt lds
    s_mov_b32 m0, 54272
    s_add_u32 s12, s12, 8192
    buffer_load_dwordx4 v14, s[48:51], s12 offen nt lds
    s_mov_b32 m0, 55296
    s_add_u32 s12, s12, 8192
    buffer_load_dwordx4 v14, s[48:51], s12 offen nt lds
    s_mov_b32 m0, 56320
    s_add_u32 s12, s12, 8192
    buffer_load_dwordx4 v14, s[48:51], s12 offen nt lds
    s_mov_b32 m0, 57344
    s_add_u32 s12, s12, 8192
    buffer_load_dwordx4 v14, s[48:51], s12 offen nt lds
    s_mov_b32 m0, 58368
    s_add_u32 s12, s12, 8192
    buffer_load_dwordx4 v14, s[48:51], s12 offen nt lds
    s_mov_b32 m0, 59392
    s_add_u32 s12, s12, 8192
    buffer_load_dwordx4 v14, s[48:51], s12 offen nt lds
    s_mov_b32 m0, 60416
    s_add_u32 s12, s12, 8192
    buffer_load_dwordx4 v14, s[48:51], s12 offen nt lds
    s_mov_b32 m0, 61440
    s_add_u32 s12, s12, 8192
    buffer_load_dwordx4 v14, s[48:51], s12 offen nt lds
    s_mov_b32 m0, 62464
    s_add_u32 s12, s12, 8192
    buffer_load_dwordx4 v14, s[48:51], s12 offen nt lds
    s_mov_b32 m0, 63488
    s_add_u32 s12, s12, 8192
    buffer_load_dwordx4 v14, s[48:51], s12 offen nt lds
    s_mov_b32 m0, 64512
    s_add_u32 s12, s12, 8192
    buffer_load_dwordx4 v14, s[48:51], s12 offen nt lds
    s_mov_b32 m0, 65536
    s_add_u32 s12, s12, 8192
    buffer_load_dwordx4 v14, s[48:51], s12 offen nt lds
    s_mov_b32 m0, 66560
    s_add_u32 s12, s12, 8192
    buffer_load_dwordx4 v14, s[48:51], s12 offen nt lds
    s_mov_b32 m0, 67584
    s_add_u32 s12, s12, 8192
    buffer_load_dwordx4 v14, s[48:51], s12 offen nt lds
    s_mov_b32 m0, 68608
    s_add_u32 s12, s12, 8192
    buffer_load_dwordx4 v14, s[48:51], s12 offen nt lds
    s_mov_b32 m0, 69632
    s_add_u32 s12, s12, 8192
    buffer_load_dwordx4 v14, s[48:51], s12 offen nt lds
    s_mov_b32 m0, 70656
    s_add_u32 s12, s12, 8192
    buffer_load_dwordx4 v14, s[48:51], s12 offen nt lds
    s_mov_b32 m0, 71680
    s_add_u32 s12, s12, 8192
    buffer_load_dwordx4 v14, s[48:51], s12 offen nt lds
    s_mov_b32 m0, 72704
    s_add_u32 s12, s12, 8192
    buffer_load_dwordx4 v14, s[48:51], s12 offen nt lds
    s_mov_b32 m0, 73728
    s_add_u32 s12, s12, 8192
    buffer_load_dwordx4 v14, s[48:51], s12 offen nt lds
    s_barrier
    s_waitcnt vmcnt(28)
    ds_read_b64_tr_b16 v[136:137], v10 offset:0
    ds_read_b64_tr_b16 v[138:139], v10 offset:512
    ds_read_b64_tr_b16 v[140:141], v10 offset:32
    ds_read_b64_tr_b16 v[142:143], v10 offset:544
    ds_read_b64_tr_b16 v[144:145], v10 offset:64
    ds_read_b64_tr_b16 v[146:147], v10 offset:576
    ds_read_b64_tr_b16 v[148:149], v10 offset:96
    ds_read_b64_tr_b16 v[150:151], v10 offset:608
    s_waitcnt lgkmcnt(0)
    s_waitcnt vmcnt(24)
    ds_read_b64_tr_b16 v[152:153], v10 offset:4096
    ds_read_b64_tr_b16 v[154:155], v10 offset:4608
    ds_read_b64_tr_b16 v[156:157], v10 offset:4128
    ds_read_b64_tr_b16 v[158:159], v10 offset:4640
    ds_read_b64_tr_b16 v[160:161], v10 offset:4160
    ds_read_b64_tr_b16 v[162:163], v10 offset:4672
    ds_read_b64_tr_b16 v[164:165], v10 offset:4192
    ds_read_b64_tr_b16 v[166:167], v10 offset:4704
    v_mfma_f32_16x16x32_bf16 v[104:107], v[72:75], v[136:139], 0
    v_mfma_f32_16x16x32_bf16 v[108:111], v[72:75], v[140:143], 0
    v_mfma_f32_16x16x32_bf16 v[112:115], v[72:75], v[144:147], 0
    v_mfma_f32_16x16x32_bf16 v[116:119], v[72:75], v[148:151], 0
    s_waitcnt lgkmcnt(0)
    s_waitcnt vmcnt(20)
    ds_read_b64_tr_b16 v[136:137], v10 offset:8192
    ds_read_b64_tr_b16 v[138:139], v10 offset:8704
    ds_read_b64_tr_b16 v[140:141], v10 offset:8224
    ds_read_b64_tr_b16 v[142:143], v10 offset:8736
    ds_read_b64_tr_b16 v[144:145], v10 offset:8256
    ds_read_b64_tr_b16 v[146:147], v10 offset:8768
    ds_read_b64_tr_b16 v[148:149], v10 offset:8288
    ds_read_b64_tr_b16 v[150:151], v10 offset:8800
    v_mfma_f32_16x16x32_bf16 v[104:107], v[76:79], v[152:155], v[104:107]
    v_mfma_f32_16x16x32_bf16 v[108:111], v[76:79], v[156:159], v[108:111]
    v_mfma_f32_16x16x32_bf16 v[112:115], v[76:79], v[160:163], v[112:115]
    v_mfma_f32_16x16x32_bf16 v[116:119], v[76:79], v[164:167], v[116:119]
    s_waitcnt lgkmcnt(0)
    s_waitcnt vmcnt(16)
    ds_read_b64_tr_b16 v[152:153], v10 offset:12288
    ds_read_b64_tr_b16 v[154:155], v10 offset:12800
    ds_read_b64_tr_b16 v[156:157], v10 offset:12320
    ds_read_b64_tr_b16 v[158:159], v10 offset:12832
    ds_read_b64_tr_b16 v[160:161], v10 offset:12352
    ds_read_b64_tr_b16 v[162:163], v10 offset:12864
    ds_read_b64_tr_b16 v[164:165], v10 offset:12384
    ds_read_b64_tr_b16 v[166:167], v10 offset:12896
    v_mfma_f32_16x16x32_bf16 v[104:107], v[80:83], v[136:139], v[104:107]
    v_mfma_f32_16x16x32_bf16 v[108:111], v[80:83], v[140:143], v[108:111]
    v_mfma_f32_16x16x32_bf16 v[112:115], v[80:83], v[144:147], v[112:115]
    v_mfma_f32_16x16x32_bf16 v[116:119], v[80:83], v[148:151], v[116:119]
    s_waitcnt lgkmcnt(0)
    s_waitcnt vmcnt(12)
    ds_read_b64_tr_b16 v[136:137], v10 offset:16384
    ds_read_b64_tr_b16 v[138:139], v10 offset:16896
    ds_read_b64_tr_b16 v[140:141], v10 offset:16416
    ds_read_b64_tr_b16 v[142:143], v10 offset:16928
    ds_read_b64_tr_b16 v[144:145], v10 offset:16448
    ds_read_b64_tr_b16 v[146:147], v10 offset:16960
    ds_read_b64_tr_b16 v[148:149], v10 offset:16480
    ds_read_b64_tr_b16 v[150:151], v10 offset:16992
    v_mfma_f32_16x16x32_bf16 v[104:107], v[84:87], v[152:155], v[104:107]
    v_mfma_f32_16x16x32_bf16 v[108:111], v[84:87], v[156:159], v[108:111]
    v_mfma_f32_16x16x32_bf16 v[112:115], v[84:87], v[160:163], v[112:115]
    v_mfma_f32_16x16x32_bf16 v[116:119], v[84:87], v[164:167], v[116:119]
    s_waitcnt lgkmcnt(0)
    s_waitcnt vmcnt(8)
    ds_read_b64_tr_b16 v[152:153], v10 offset:20480
    ds_read_b64_tr_b16 v[154:155], v10 offset:20992
    ds_read_b64_tr_b16 v[156:157], v10 offset:20512
    ds_read_b64_tr_b16 v[158:159], v10 offset:21024
    ds_read_b64_tr_b16 v[160:161], v10 offset:20544
    ds_read_b64_tr_b16 v[162:163], v10 offset:21056
    ds_read_b64_tr_b16 v[164:165], v10 offset:20576
    ds_read_b64_tr_b16 v[166:167], v10 offset:21088
    v_mfma_f32_16x16x32_bf16 v[104:107], v[88:91], v[136:139], v[104:107]
    v_mfma_f32_16x16x32_bf16 v[108:111], v[88:91], v[140:143], v[108:111]
    v_mfma_f32_16x16x32_bf16 v[112:115], v[88:91], v[144:147], v[112:115]
    v_mfma_f32_16x16x32_bf16 v[116:119], v[88:91], v[148:151], v[116:119]
    s_waitcnt lgkmcnt(0)
    s_waitcnt vmcnt(4)
    ds_read_b64_tr_b16 v[136:137], v10 offset:24576
    ds_read_b64_tr_b16 v[138:139], v10 offset:25088
    ds_read_b64_tr_b16 v[140:141], v10 offset:24608
    ds_read_b64_tr_b16 v[142:143], v10 offset:25120
    ds_read_b64_tr_b16 v[144:145], v10 offset:24640
    ds_read_b64_tr_b16 v[146:147], v10 offset:25152
    ds_read_b64_tr_b16 v[148:149], v10 offset:24672
    ds_read_b64_tr_b16 v[150:151], v10 offset:25184
    v_mfma_f32_16x16x32_bf16 v[104:107], v[92:95], v[152:155], v[104:107]
    v_mfma_f32_16x16x32_bf16 v[108:111], v[92:95], v[156:159], v[108:111]
    v_mfma_f32_16x16x32_bf16 v[112:115], v[92:95], v[160:163], v[112:115]
    v_mfma_f32_16x16x32_bf16 v[116:119], v[92:95], v[164:167], v[116:119]
    s_waitcnt lgkmcnt(0)
    s_waitcnt vmcnt(0)
    ds_read_b64_tr_b16 v[152:153], v10 offset:28672
    ds_read_b64_tr_b16 v[154:155], v10 offset:29184
    ds_read_b64_tr_b16 v[156:157], v10 offset:28704
    ds_read_b64_tr_b16 v[158:159], v10 offset:29216
    ds_read_b64_tr_b16 v[160:161], v10 offset:28736
    ds_read_b64_tr_b16 v[162:163], v10 offset:29248
    ds_read_b64_tr_b16 v[164:165], v10 offset:28768
    ds_read_b64_tr_b16 v[166:167], v10 offset:29280
    v_mfma_f32_16x16x32_bf16 v[104:107], v[96:99], v[136:139], v[104:107]
    v_mfma_f32_16x16x32_bf16 v[108:111], v[96:99], v[140:143], v[108:111]
    v_mfma_f32_16x16x32_bf16 v[112:115], v[96:99], v[144:147], v[112:115]
    v_mfma_f32_16x16x32_bf16 v[116:119], v[96:99], v[148:151], v[116:119]
    s_waitcnt lgkmcnt(0)
    v_mfma_f32_16x16x32_bf16 v[104:107], v[100:103], v[152:155], v[104:107]
    v_mfma_f32_16x16x32_bf16 v[108:111], v[100:103], v[156:159], v[108:111]
    v_mfma_f32_16x16x32_bf16 v[112:115], v[100:103], v[160:163], v[112:115]
    v_mfma_f32_16x16x32_bf16 v[116:119], v[100:103], v[164:167], v[116:119]
    v_mov_b32 v21, s68
    v_mov_b32 v23, s68
    v_mov_b32 v25, s68
    v_mov_b32 v27, s68
    s_nop 1
    v_cndmask_b32 v104, v104, v108, s[58:59]
    v_cndmask_b32 v105, v105, v109, s[58:59]
    v_cndmask_b32 v106, v106, v110, s[58:59]
    v_cndmask_b32 v107, v107, v111, s[58:59]
    v_cndmask_b32 v20, v104, v106, s[56:57]
    v_cndmask_b32 v22, v105, v107, s[56:57]
    v_cndmask_b32 v112, v112, v116, s[58:59]
    v_cndmask_b32 v113, v113, v117, s[58:59]
    v_cndmask_b32 v114, v114, v118, s[58:59]
    v_cndmask_b32 v115, v115, v119, s[58:59]
    v_cndmask_b32 v24, v112, v114, s[56:57]
    v_cndmask_b32 v26, v113, v115, s[56:57]
    s_add_u32 s9, s13, 16384
    buffer_store_dwordx4 v[20:23], v11, s[64:67], s13 offen sc1
    buffer_store_dwordx4 v[24:27], v11, s[64:67], s9 offen sc1
L_svc_end:
L_fin:
L_end:
    s_endpgm
.section .rodata,"a"
.p2align 6
.amdhsa_kernel recurrent_scan__gqa_block_cached__swiglu_ffn__decode_kernel
.amdhsa_next_free_vgpr 168
.amdhsa_next_free_sgpr 102
.amdhsa_accum_offset 168
.amdhsa_group_segment_fixed_size 0
.amdhsa_kernarg_size 96
.amdhsa_user_sgpr_count 2
.amdhsa_user_sgpr_kernarg_segment_ptr 1
.amdhsa_system_sgpr_workgroup_id_x 1
.amdhsa_float_denorm_mode_32 3
.end_amdhsa_kernel
```
